```python
import torch

def _softmax(x, axis=-1):
    return torch.softmax(x, dim=axis)
def _gelu(x):
    return torch.nn.functional.gelu(x, approximate="tanh")
def _silu(x):
    return torch.nn.functional.silu(x)
def _sigmoid(x):
    return torch.sigmoid(x)
def _layernorm(x, axis=-1, eps=1e-5):
    m = x.mean(dim=axis, keepdim=True)
    v = x.var(dim=axis, keepdim=True, unbiased=False)
    return (x - m) / torch.sqrt(v + eps)
def _scatter_add(tgt, idx, src, axis=0):
    return tgt.clone().index_add_(axis, idx, src)
def _segment_sum(src, seg, n):
    out = torch.zeros((n,) + src.shape[1:], dtype=src.dtype)
    return out.index_add_(0, seg, src)
def _pad(x, pw):
    flat = tuple(v for pair in reversed(pw) for v in pair)
    return torch.nn.functional.pad(x, flat)

kernel_name = 'standalone__edge_featured_mpnn_gatedgcn__graph'

def setup_inputs():

    _w = (lambda a: (lambda t: t.to(torch.bfloat16) if t.is_floating_point() else t)(torch.as_tensor(a)))
    N, deg, D, De = 12500, 32, 128, max(16, 1)
    E = N * deg
    return {
        "x": _w((lambda *s: torch.randn(*s, dtype=torch.bfloat16) * 0.4)(N, D)),
        "e_attr": _w((lambda *s: torch.randn(*s, dtype=torch.bfloat16) * 0.8)(E, De)),
        "src": _w((lambda lo, hi, *s: torch.randint(lo, hi, s))(0, N, E).to(torch.int64)),
        "dst": _w((lambda lo, hi, *s: torch.randint(lo, hi, s))(0, N, E).to(torch.int64)),
        "w_a": _w((lambda *s: torch.randn(*s, dtype=torch.bfloat16) * 0.4)(D, D)),
        "w_b": _w((lambda *s: torch.randn(*s, dtype=torch.bfloat16) * 0.4)(D, D)),
        "w_c": _w((lambda *s: torch.randn(*s, dtype=torch.bfloat16) * 0.8)(De, D)),
        "w_u": _w((lambda *s: torch.randn(*s, dtype=torch.bfloat16) * 0.05)(D, D)),
        "w_v": _w((lambda *s: torch.randn(*s, dtype=torch.bfloat16) * 0.05)(D, D)),
    }

def reference(x, e_attr, src, dst, w_a, w_b, w_c, w_u, w_v):
    N, D = x.shape
    hv = x @ w_v
    g = x[dst] @ w_a + x[src] @ w_b + e_attr @ w_c
    eta = _sigmoid(g)
    denom = _segment_sum(eta, dst, N) + 1e-6
    eta_n = eta / denom[dst]
    agg = _segment_sum(eta_n * hv[src], dst, N)
    z = x @ w_u + agg
    relu_z = torch.where(z > 0, z, 0 * z)
    return x + relu_z
```

```asm
; @launch kernel=prep_kernel grid=(256,1,1) block=(512,1,1) lds=90112
; @launch kernel=edge_kernel grid=(256,1,1) block=(512,1,1) lds=163840
.amdgcn_target "amdgcn-amd-amdhsa--gfx950"
.text
.globl prep_kernel
.p2align 8
.type prep_kernel,@function
prep_kernel:
    s_cmp_ge_u32 s2, 256
    s_cbranch_scc1 P_end
    s_load_dwordx16 s[8:23], s[0:1], 0
    s_load_dwordx8 s[24:31], s[0:1], 64
    s_cmp_ge_u32 s2, 16
    s_cbranch_scc1 P_w1
    s_getpc_b64 s[64:65]

P_pc:
    v_lshlrev_b32 v60, 7, v0
    v_mov_b32 v61, s65
    v_cmp_gt_u32 vcc, E_end-P_pc, v60
    s_and_saveexec_b64 s[66:67], vcc
    s_cbranch_execz P_w0
    v_add_co_u32 v60, vcc, s64, v60
    s_nop 1
    v_addc_co_u32 v61, vcc, 0, v61, vcc
    global_load_dword v124, v[60:61], off

P_w0:
    s_mov_b64 exec, s[66:67]
P_w1:
    v_lshrrev_b32 v1, 6, v0
    v_and_b32 v2, 63, v0
    v_readfirstlane_b32 s3, v1
    s_and_b32 s5, s2, 7
    s_lshr_b32 s6, s2, 3
    s_mov_b32 s2, s6
    s_cmp_eq_u32 s5, 0
    s_cbranch_scc1 P_bin
    s_mul_i32 s7, s6, 7
    s_add_u32 s7, s7, s5
    s_add_u32 s2, s7, 31
    s_cmp_lt_u32 s7, 92
    s_cbranch_scc1 P_bin
    s_sub_u32 s4, s7, 92

    v_lshrrev_b32 v3, 4, v2
    s_lshl_b32 s5, s3, 2
    v_and_b32 v4, 15, v2
    s_mul_i32 s7, s4, 96
    v_lshlrev_b32 v5, 2, v3
    s_and_b32 s45, s3, 3
    v_xor_b32 v5, v4, v5
    s_lshr_b32 s46, s3, 2
    v_lshlrev_b32 v5, 4, v5
    s_lshl_b32 s47, s45, 2
    v_lshl_or_b32 v5, v3, 8, v5
    v_add_u32 v6, s5, v3
    v_and_b32 v7, 15, v6
    v_xor_b32 v7, v4, v7
    v_add_u32 v6, s7, v6
    v_lshlrev_b32 v6, 8, v6
    v_lshl_add_u32 v120, v7, 4, v6
    v_add_u32 v121, 8192, v120
    v_add_u32 v122, 16384, v120
    v_lshrrev_b32 v9, 1, v3
    v_lshrrev_b32 v10, 2, v4
    v_and_b32 v11, 3, v4
    v_and_b32 v12, 1, v3
    v_lshlrev_b32 v12, 1, v12
    v_lshrrev_b32 v13, 1, v11
    v_add_u32 v12, v12, v13
    v_add_u32 v12, s47, v12
    v_lshlrev_b32 v13, 2, v10
    v_xor_b32 v12, v12, v13
    v_lshlrev_b32 v12, 4, v12
    v_and_b32 v13, 1, v11
    v_lshl_add_u32 v12, v13, 3, v12
    v_lshl_add_u32 v13, v9, 3, v10
    v_lshl_add_u32 v12, v13, 8, v12
    v_and_b32 v13, 31, v2
    s_lshl_b32 s47, s46, 5
    v_add_u32 v14, s47, v13
    s_lshr_b32 s49, s45, 1
    v_lshlrev_b32 v14, 8, v14
    s_lshl_b32 s48, s49, 8
    v_xor_b32 v15, v9, v4
    s_lshl_b32 s49, s46, 14
    v_lshl_or_b32 v14, v15, 4, v14
    s_add_u32 s48, s48, s49
    v_add_u32 v14, 0x10000, v14
    s_and_b32 s49, s45, 1
    v_lshlrev_b32 v15, 11, v9
    s_lshl_b32 s49, s49, 6
    v_and_b32 v10, 1, v13
    s_add_u32 s48, s48, s49
    v_lshl_add_u32 v15, v10, 7, v15
    v_lshrrev_b32 v6, 1, v13
    v_lshl_add_u32 v15, v6, 2, v15
    v_add_u32 v15, s48, v15
    s_mov_b32 s34, 0x8000
    s_mov_b32 s35, 0x00020000
    s_mov_b32 s38, 0x8000
    s_mov_b32 s39, 0x00020000
    s_mov_b32 s42, 3200000
    s_mov_b32 s43, 0x00020000
    s_sub_u32 s44, s6, 13
    s_mul_i32 s44, s44, 1792
    v_lshl_add_u32 v123, v2, 7, s44
    s_lshl_b32 s7, s3, 10
    s_waitcnt lgkmcnt(0)

    s_mov_b32 s32, s18
    s_mov_b32 s33, s19
    s_mov_b32 s36, s24
    s_mov_b32 s37, s25
    s_mov_b32 s40, s8
    s_mov_b32 s41, s9
    s_cmp_lt_u32 s4, 131
    s_cbranch_scc1 P_g1
    s_cmp_eq_u32 s4, 131
    s_cselect_b32 s32, s16, s22
    s_cselect_b32 s33, s17, s23
    s_mov_b32 s38, 0
    s_mov_b32 s40, s20
    s_mov_b32 s41, s21
    s_mov_b32 s42, 4096
    v_add_u32 v120, s7, v5

P_g1:
    s_cmp_lg_u32 s3, 0
    s_cbranch_scc1 P_g0
    s_mov_b64 exec, 0x3fff
    buffer_load_dword v126, v123, s[32:35], 0 offen
    buffer_load_dword v127, v123, s[36:39], 0 offen
    s_mov_b64 exec, -1

P_g0:
    s_add_u32 s62, s7, 0x10000
    s_mov_b32 m0, s7
    s_add_u32 s44, s7, 0x8000
    buffer_load_dwordx4 v5, s[32:35], s7 offen lds
    s_mov_b32 m0, s44
    s_nop 0
    buffer_load_dwordx4 v5, s[36:39], s7 offen lds
    s_add_u32 s7, s7, 8192
    s_barrier
    s_mov_b32 m0, s7
    s_add_u32 s44, s7, 0x8000
    buffer_load_dwordx4 v5, s[32:35], s7 offen lds
    s_mov_b32 m0, s44
    s_nop 0
    buffer_load_dwordx4 v5, s[36:39], s7 offen lds
    s_add_u32 s7, s7, 8192
    s_barrier
    s_mov_b32 m0, s7
    s_add_u32 s44, s7, 0x8000
    buffer_load_dwordx4 v5, s[32:35], s7 offen lds
    s_mov_b32 m0, s44
    s_nop 0
    buffer_load_dwordx4 v5, s[36:39], s7 offen lds
    s_add_u32 s7, s7, 8192
    s_barrier
    s_mov_b32 m0, s7
    s_add_u32 s44, s7, 0x8000
    buffer_load_dwordx4 v5, s[32:35], s7 offen lds
    s_mov_b32 m0, s44
    s_nop 0
    buffer_load_dwordx4 v5, s[36:39], s7 offen lds
    s_mov_b32 m0, s62
    s_add_u32 s62, s62, 8192
    buffer_load_dwordx4 v120, s[40:43], 0 offen lds
    s_mov_b32 m0, s62
    s_add_u32 s62, s62, 8192
    buffer_load_dwordx4 v121, s[40:43], 0 offen lds
    s_mov_b32 m0, s62
    s_add_u32 s62, s62, 8192
    buffer_load_dwordx4 v122, s[40:43], 0 offen lds
    s_add_u32 s52, s30, 0x1000
    s_addc_u32 s53, s31, 0
    s_mov_b32 s54, 0x800000
    s_mov_b32 s55, 0x20000
    s_mov_b32 s59, 0xbfb8aa3b
    s_mov_b32 s60, 0x07060100
    s_mov_b32 s61, 0x07060302
    s_mul_i32 s47, s4, 3
    s_add_u32 s48, s46, s47
    s_add_u32 s47, s47, 2
    s_mul_i32 s49, s48, 21400
    s_mul_i32 s50, s47, 21400
    s_lshr_b32 s49, s49, 21
    s_lshr_b32 s50, s50, 21
    s_mul_i32 s49, s49, 491520
    s_mul_i32 s50, s50, 491520
    s_lshl_b32 s48, s48, 14
    s_lshl_b32 s47, s47, 14
    s_add_u32 s48, s48, s49
    s_add_u32 s47, s47, s50
    s_lshl_b32 s49, s45, 12
    s_add_u32 s48, s48, s49
    s_lshl_b32 s49, s3, 11
    s_add_u32 s47, s47, s49
    v_lshlrev_b32 v1, 4, v2
    v_add_u32 v3, s48, v1
    v_add_u32 v5, s47, v1
    s_add_u32 s49, s49, 0x8000
    v_add_u32 v7, s49, v1
    s_lshl_b32 s49, s3, 12
    v_add_u32 v8, s49, v1

    s_waitcnt vmcnt(7)
    s_barrier
    ds_read_b64_tr_b16 v[16:17], v12 offset:0
    ds_read_b64_tr_b16 v[18:19], v12 offset:1024
    ds_read_b64_tr_b16 v[48:49], v12 offset:32768
    ds_read_b64_tr_b16 v[50:51], v12 offset:33792
    ds_read_b64_tr_b16 v[20:21], v12 offset:4096
    ds_read_b64_tr_b16 v[22:23], v12 offset:5120
    ds_read_b64_tr_b16 v[52:53], v12 offset:36864
    ds_read_b64_tr_b16 v[54:55], v12 offset:37888
    ds_read_b64_tr_b16 v[24:25], v12 offset:8192
    ds_read_b64_tr_b16 v[26:27], v12 offset:9216
    ds_read_b64_tr_b16 v[56:57], v12 offset:40960
    ds_read_b64_tr_b16 v[58:59], v12 offset:41984
    ds_read_b64_tr_b16 v[28:29], v12 offset:12288
    ds_read_b64_tr_b16 v[30:31], v12 offset:13312
    ds_read_b64_tr_b16 v[60:61], v12 offset:45056
    ds_read_b64_tr_b16 v[62:63], v12 offset:46080
    s_waitcnt vmcnt(3)
    s_barrier
    ds_read_b64_tr_b16 v[32:33], v12 offset:16384
    ds_read_b64_tr_b16 v[34:35], v12 offset:17408
    ds_read_b64_tr_b16 v[64:65], v12 offset:49152
    ds_read_b64_tr_b16 v[66:67], v12 offset:50176
    ds_read_b64_tr_b16 v[36:37], v12 offset:20480
    ds_read_b64_tr_b16 v[38:39], v12 offset:21504
    ds_read_b64_tr_b16 v[68:69], v12 offset:53248
    ds_read_b64_tr_b16 v[70:71], v12 offset:54272
    ds_read_b64_tr_b16 v[40:41], v12 offset:24576
    ds_read_b64_tr_b16 v[42:43], v12 offset:25600
    ds_read_b64_tr_b16 v[72:73], v12 offset:57344
    ds_read_b64_tr_b16 v[74:75], v12 offset:58368
    ds_read_b64_tr_b16 v[44:45], v12 offset:28672
    ds_read_b64_tr_b16 v[46:47], v12 offset:29696
    ds_read_b64_tr_b16 v[76:77], v12 offset:61440
    ds_read_b64_tr_b16 v[78:79], v12 offset:62464
    v_xor_b32 v112, 0, v14
    v_xor_b32 v113, 32, v14
    v_xor_b32 v114, 64, v14
    v_xor_b32 v115, 96, v14
    v_xor_b32 v116, 128, v14
    v_xor_b32 v117, 160, v14
    v_xor_b32 v118, 192, v14
    v_xor_b32 v119, 224, v14
    s_waitcnt vmcnt(0) lgkmcnt(0)
    s_cmp_ge_u32 s4, 131
    s_cbranch_scc1 P_wfrag
    s_barrier
    ds_read_b128 v[144:147], v112
    ds_read_b128 v[148:151], v113
    ds_read_b128 v[152:155], v114
    ds_read_b128 v[156:159], v115
    ds_read_b128 v[160:163], v116
    ds_read_b128 v[164:167], v117
    ds_read_b128 v[168:171], v118
    ds_read_b128 v[172:175], v119
    s_waitcnt lgkmcnt(7)
    v_mfma_f32_32x32x16_bf16 v[80:95], v[144:147], v[16:19], 0
    v_mfma_f32_32x32x16_bf16 v[96:111], v[144:147], v[48:51], 0
    s_waitcnt lgkmcnt(6)
    v_mfma_f32_32x32x16_bf16 v[80:95], v[148:151], v[20:23], v[80:95]
    v_mfma_f32_32x32x16_bf16 v[96:111], v[148:151], v[52:55], v[96:111]
    s_waitcnt lgkmcnt(5)
    v_mfma_f32_32x32x16_bf16 v[80:95], v[152:155], v[24:27], v[80:95]
    v_mfma_f32_32x32x16_bf16 v[96:111], v[152:155], v[56:59], v[96:111]
    s_waitcnt lgkmcnt(4)
    v_mfma_f32_32x32x16_bf16 v[80:95], v[156:159], v[28:31], v[80:95]
    v_mfma_f32_32x32x16_bf16 v[96:111], v[156:159], v[60:63], v[96:111]
    s_waitcnt lgkmcnt(3)
    v_mfma_f32_32x32x16_bf16 v[80:95], v[160:163], v[32:35], v[80:95]
    v_mfma_f32_32x32x16_bf16 v[96:111], v[160:163], v[64:67], v[96:111]
    s_waitcnt lgkmcnt(2)
    v_mfma_f32_32x32x16_bf16 v[80:95], v[164:167], v[36:39], v[80:95]
    v_mfma_f32_32x32x16_bf16 v[96:111], v[164:167], v[68:71], v[96:111]
    s_waitcnt lgkmcnt(1)
    v_mfma_f32_32x32x16_bf16 v[80:95], v[168:171], v[40:43], v[80:95]
    v_mfma_f32_32x32x16_bf16 v[96:111], v[168:171], v[72:75], v[96:111]
    s_waitcnt lgkmcnt(0)
    v_mfma_f32_32x32x16_bf16 v[80:95], v[172:175], v[44:47], v[80:95]
    v_mfma_f32_32x32x16_bf16 v[96:111], v[172:175], v[76:79], v[96:111]
    s_cmp_ge_u32 s3, 4
    s_cbranch_scc1 P_g2
    ds_read_b128 v[176:179], v112 offset:16384
    ds_read_b128 v[180:183], v113 offset:16384
    ds_read_b128 v[184:187], v114 offset:16384
    ds_read_b128 v[188:191], v115 offset:16384
    ds_read_b128 v[192:195], v116 offset:16384
    ds_read_b128 v[196:199], v117 offset:16384
    ds_read_b128 v[200:203], v118 offset:16384
    ds_read_b128 v[204:207], v119 offset:16384
    s_nop 1
    v_mul_f32 v80, 0xbf38aa3b, v80
    v_mul_f32 v81, 0xbf38aa3b, v81
    v_mul_f32 v82, 0xbf38aa3b, v82
    v_mul_f32 v83, 0xbf38aa3b, v83
    v_mul_f32 v84, 0xbf38aa3b, v84
    v_mul_f32 v85, 0xbf38aa3b, v85
    v_mul_f32 v86, 0xbf38aa3b, v86
    v_mul_f32 v87, 0xbf38aa3b, v87
    v_mul_f32 v88, 0xbf38aa3b, v88
    v_mul_f32 v89, 0xbf38aa3b, v89
    v_mul_f32 v90, 0xbf38aa3b, v90
    v_mul_f32 v91, 0xbf38aa3b, v91
    v_mul_f32 v92, 0xbf38aa3b, v92
    v_mul_f32 v93, 0xbf38aa3b, v93
    v_mul_f32 v94, 0xbf38aa3b, v94
    v_mul_f32 v95, 0xbf38aa3b, v95
    v_add_f32 v96, 0, v96
    v_add_f32 v97, 0, v97
    v_add_f32 v98, 0, v98
    v_add_f32 v99, 0, v99
    v_add_f32 v100, 0, v100
    v_add_f32 v101, 0, v101
    v_add_f32 v102, 0, v102
    v_add_f32 v103, 0, v103
    v_add_f32 v104, 0, v104
    v_add_f32 v105, 0, v105
    v_add_f32 v106, 0, v106
    v_add_f32 v107, 0, v107
    v_add_f32 v108, 0, v108
    v_add_f32 v109, 0, v109
    v_add_f32 v110, 0, v110
    v_add_f32 v111, 0, v111
    v_add_u32 v96, 0x8000, v96
    v_add_u32 v97, 0x8000, v97
    v_add_u32 v98, 0x8000, v98
    v_add_u32 v99, 0x8000, v99
    v_add_u32 v100, 0x8000, v100
    v_add_u32 v101, 0x8000, v101
    v_add_u32 v102, 0x8000, v102
    v_add_u32 v103, 0x8000, v103
    v_add_u32 v104, 0x8000, v104
    v_add_u32 v105, 0x8000, v105
    v_add_u32 v106, 0x8000, v106
    v_add_u32 v107, 0x8000, v107
    v_add_u32 v108, 0x8000, v108
    v_add_u32 v109, 0x8000, v109
    v_add_u32 v110, 0x8000, v110
    v_add_u32 v111, 0x8000, v111
    v_cvt_pk_bf16_f32 v80, v80, v81
    v_cvt_pk_bf16_f32 v82, v82, v83
    v_cvt_pk_bf16_f32 v84, v84, v85
    v_cvt_pk_bf16_f32 v86, v86, v87
    v_cvt_pk_bf16_f32 v88, v88, v89
    v_cvt_pk_bf16_f32 v90, v90, v91
    v_cvt_pk_bf16_f32 v92, v92, v93
    v_cvt_pk_bf16_f32 v94, v94, v95
    v_sub_u32_sdwa v96, v96, v80 clamp dst_sel:DWORD dst_unused:UNUSED_PAD src0_sel:DWORD src1_sel:WORD_0
    v_sub_u32_sdwa v97, v97, v80 clamp dst_sel:DWORD dst_unused:UNUSED_PAD src0_sel:DWORD src1_sel:WORD_1
    v_sub_u32_sdwa v98, v98, v82 clamp dst_sel:DWORD dst_unused:UNUSED_PAD src0_sel:DWORD src1_sel:WORD_0
    v_sub_u32_sdwa v99, v99, v82 clamp dst_sel:DWORD dst_unused:UNUSED_PAD src0_sel:DWORD src1_sel:WORD_1
    v_sub_u32_sdwa v100, v100, v84 clamp dst_sel:DWORD dst_unused:UNUSED_PAD src0_sel:DWORD src1_sel:WORD_0
    v_sub_u32_sdwa v101, v101, v84 clamp dst_sel:DWORD dst_unused:UNUSED_PAD src0_sel:DWORD src1_sel:WORD_1
    v_sub_u32_sdwa v102, v102, v86 clamp dst_sel:DWORD dst_unused:UNUSED_PAD src0_sel:DWORD src1_sel:WORD_0
    v_sub_u32_sdwa v103, v103, v86 clamp dst_sel:DWORD dst_unused:UNUSED_PAD src0_sel:DWORD src1_sel:WORD_1
    v_sub_u32_sdwa v104, v104, v88 clamp dst_sel:DWORD dst_unused:UNUSED_PAD src0_sel:DWORD src1_sel:WORD_0
    v_sub_u32_sdwa v105, v105, v88 clamp dst_sel:DWORD dst_unused:UNUSED_PAD src0_sel:DWORD src1_sel:WORD_1
    v_sub_u32_sdwa v106, v106, v90 clamp dst_sel:DWORD dst_unused:UNUSED_PAD src0_sel:DWORD src1_sel:WORD_0
    v_sub_u32_sdwa v107, v107, v90 clamp dst_sel:DWORD dst_unused:UNUSED_PAD src0_sel:DWORD src1_sel:WORD_1
    v_sub_u32_sdwa v108, v108, v92 clamp dst_sel:DWORD dst_unused:UNUSED_PAD src0_sel:DWORD src1_sel:WORD_0
    v_sub_u32_sdwa v109, v109, v92 clamp dst_sel:DWORD dst_unused:UNUSED_PAD src0_sel:DWORD src1_sel:WORD_1
    v_sub_u32_sdwa v110, v110, v94 clamp dst_sel:DWORD dst_unused:UNUSED_PAD src0_sel:DWORD src1_sel:WORD_0
    v_sub_u32_sdwa v111, v111, v94 clamp dst_sel:DWORD dst_unused:UNUSED_PAD src0_sel:DWORD src1_sel:WORD_1
    v_perm_b32 v96, v96, v80, s60
    v_perm_b32 v97, v97, v80, s61
    v_perm_b32 v98, v98, v82, s60
    v_perm_b32 v99, v99, v82, s61
    v_perm_b32 v100, v100, v84, s60
    v_perm_b32 v101, v101, v84, s61
    v_perm_b32 v102, v102, v86, s60
    v_perm_b32 v103, v103, v86, s61
    v_perm_b32 v104, v104, v88, s60
    v_perm_b32 v105, v105, v88, s61
    v_perm_b32 v106, v106, v90, s60
    v_perm_b32 v107, v107, v90, s61
    v_perm_b32 v108, v108, v92, s60
    v_perm_b32 v109, v109, v92, s61
    v_perm_b32 v110, v110, v94, s60
    v_perm_b32 v111, v111, v94, s61
    ds_write2st64_b32 v15, v96, v97 offset0:0 offset1:2
    ds_write2st64_b32 v15, v98, v99 offset0:4 offset1:6
    ds_write2st64_b32 v15, v100, v101 offset0:16 offset1:18
    ds_write2st64_b32 v15, v102, v103 offset0:20 offset1:22
    ds_write2st64_b32 v15, v104, v105 offset0:32 offset1:34
    ds_write2st64_b32 v15, v106, v107 offset0:36 offset1:38
    ds_write2st64_b32 v15, v108, v109 offset0:48 offset1:50
    ds_write2st64_b32 v15, v110, v111 offset0:52 offset1:54
    s_waitcnt lgkmcnt(0)
    s_barrier
    ds_read_b128 v[128:131], v8 offset:0
    ds_read_b128 v[132:135], v8 offset:1024
    ds_read_b128 v[136:139], v8 offset:2048
    ds_read_b128 v[140:143], v8 offset:3072
    v_mfma_f32_32x32x16_bf16 v[80:95], v[176:179], v[16:19], 0
    v_mfma_f32_32x32x16_bf16 v[96:111], v[176:179], v[48:51], 0
    v_mfma_f32_32x32x16_bf16 v[80:95], v[180:183], v[20:23], v[80:95]
    v_mfma_f32_32x32x16_bf16 v[96:111], v[180:183], v[52:55], v[96:111]
    v_mfma_f32_32x32x16_bf16 v[80:95], v[184:187], v[24:27], v[80:95]
    v_mfma_f32_32x32x16_bf16 v[96:111], v[184:187], v[56:59], v[96:111]
    s_waitcnt lgkmcnt(3)
    buffer_store_dwordx4 v[128:131], v3, s[52:55], 0 offen offset:0 sc1
    v_mfma_f32_32x32x16_bf16 v[80:95], v[188:191], v[28:31], v[80:95]
    v_mfma_f32_32x32x16_bf16 v[96:111], v[188:191], v[60:63], v[96:111]
    s_waitcnt lgkmcnt(2)
    buffer_store_dwordx4 v[132:135], v3, s[52:55], 0 offen offset:1024 sc1
    v_mfma_f32_32x32x16_bf16 v[80:95], v[192:195], v[32:35], v[80:95]
    v_mfma_f32_32x32x16_bf16 v[96:111], v[192:195], v[64:67], v[96:111]
    s_waitcnt lgkmcnt(1)
    buffer_store_dwordx4 v[136:139], v3, s[52:55], 0 offen offset:2048 sc1
    v_mfma_f32_32x32x16_bf16 v[80:95], v[196:199], v[36:39], v[80:95]
    v_mfma_f32_32x32x16_bf16 v[96:111], v[196:199], v[68:71], v[96:111]
    s_waitcnt lgkmcnt(0)
    buffer_store_dwordx4 v[140:143], v3, s[52:55], 0 offen offset:3072 sc1
    v_mfma_f32_32x32x16_bf16 v[80:95], v[200:203], v[40:43], v[80:95]
    v_mfma_f32_32x32x16_bf16 v[96:111], v[200:203], v[72:75], v[96:111]
    v_mfma_f32_32x32x16_bf16 v[80:95], v[204:207], v[44:47], v[80:95]
    v_mfma_f32_32x32x16_bf16 v[96:111], v[204:207], v[76:79], v[96:111]
    s_barrier
    s_nop 9
    v_mul_f32 v80, 0xbf38aa3b, v80
    v_mul_f32 v81, 0xbf38aa3b, v81
    v_mul_f32 v82, 0xbf38aa3b, v82
    v_mul_f32 v83, 0xbf38aa3b, v83
    v_mul_f32 v84, 0xbf38aa3b, v84
    v_mul_f32 v85, 0xbf38aa3b, v85
    v_mul_f32 v86, 0xbf38aa3b, v86
    v_mul_f32 v87, 0xbf38aa3b, v87
    v_mul_f32 v88, 0xbf38aa3b, v88
    v_mul_f32 v89, 0xbf38aa3b, v89
    v_mul_f32 v90, 0xbf38aa3b, v90
    v_mul_f32 v91, 0xbf38aa3b, v91
    v_mul_f32 v92, 0xbf38aa3b, v92
    v_mul_f32 v93, 0xbf38aa3b, v93
    v_mul_f32 v94, 0xbf38aa3b, v94
    v_mul_f32 v95, 0xbf38aa3b, v95
    v_add_f32 v96, 0, v96
    v_add_f32 v97, 0, v97
    v_add_f32 v98, 0, v98
    v_add_f32 v99, 0, v99
    v_add_f32 v100, 0, v100
    v_add_f32 v101, 0, v101
    v_add_f32 v102, 0, v102
    v_add_f32 v103, 0, v103
    v_add_f32 v104, 0, v104
    v_add_f32 v105, 0, v105
    v_add_f32 v106, 0, v106
    v_add_f32 v107, 0, v107
    v_add_f32 v108, 0, v108
    v_add_f32 v109, 0, v109
    v_add_f32 v110, 0, v110
    v_add_f32 v111, 0, v111
    v_add_u32 v96, 0x8000, v96
    v_add_u32 v97, 0x8000, v97
    v_add_u32 v98, 0x8000, v98
    v_add_u32 v99, 0x8000, v99
    v_add_u32 v100, 0x8000, v100
    v_add_u32 v101, 0x8000, v101
    v_add_u32 v102, 0x8000, v102
    v_add_u32 v103, 0x8000, v103
    v_add_u32 v104, 0x8000, v104
    v_add_u32 v105, 0x8000, v105
    v_add_u32 v106, 0x8000, v106
    v_add_u32 v107, 0x8000, v107
    v_add_u32 v108, 0x8000, v108
    v_add_u32 v109, 0x8000, v109
    v_add_u32 v110, 0x8000, v110
    v_add_u32 v111, 0x8000, v111
    v_cvt_pk_bf16_f32 v80, v80, v81
    v_cvt_pk_bf16_f32 v82, v82, v83
    v_cvt_pk_bf16_f32 v84, v84, v85
    v_cvt_pk_bf16_f32 v86, v86, v87
    v_cvt_pk_bf16_f32 v88, v88, v89
    v_cvt_pk_bf16_f32 v90, v90, v91
    v_cvt_pk_bf16_f32 v92, v92, v93
    v_cvt_pk_bf16_f32 v94, v94, v95
    v_sub_u32_sdwa v96, v96, v80 clamp dst_sel:DWORD dst_unused:UNUSED_PAD src0_sel:DWORD src1_sel:WORD_0
    v_sub_u32_sdwa v97, v97, v80 clamp dst_sel:DWORD dst_unused:UNUSED_PAD src0_sel:DWORD src1_sel:WORD_1
    v_sub_u32_sdwa v98, v98, v82 clamp dst_sel:DWORD dst_unused:UNUSED_PAD src0_sel:DWORD src1_sel:WORD_0
    v_sub_u32_sdwa v99, v99, v82 clamp dst_sel:DWORD dst_unused:UNUSED_PAD src0_sel:DWORD src1_sel:WORD_1
    v_sub_u32_sdwa v100, v100, v84 clamp dst_sel:DWORD dst_unused:UNUSED_PAD src0_sel:DWORD src1_sel:WORD_0
    v_sub_u32_sdwa v101, v101, v84 clamp dst_sel:DWORD dst_unused:UNUSED_PAD src0_sel:DWORD src1_sel:WORD_1
    v_sub_u32_sdwa v102, v102, v86 clamp dst_sel:DWORD dst_unused:UNUSED_PAD src0_sel:DWORD src1_sel:WORD_0
    v_sub_u32_sdwa v103, v103, v86 clamp dst_sel:DWORD dst_unused:UNUSED_PAD src0_sel:DWORD src1_sel:WORD_1
    v_sub_u32_sdwa v104, v104, v88 clamp dst_sel:DWORD dst_unused:UNUSED_PAD src0_sel:DWORD src1_sel:WORD_0
    v_sub_u32_sdwa v105, v105, v88 clamp dst_sel:DWORD dst_unused:UNUSED_PAD src0_sel:DWORD src1_sel:WORD_1
    v_sub_u32_sdwa v106, v106, v90 clamp dst_sel:DWORD dst_unused:UNUSED_PAD src0_sel:DWORD src1_sel:WORD_0
    v_sub_u32_sdwa v107, v107, v90 clamp dst_sel:DWORD dst_unused:UNUSED_PAD src0_sel:DWORD src1_sel:WORD_1
    v_sub_u32_sdwa v108, v108, v92 clamp dst_sel:DWORD dst_unused:UNUSED_PAD src0_sel:DWORD src1_sel:WORD_0
    v_sub_u32_sdwa v109, v109, v92 clamp dst_sel:DWORD dst_unused:UNUSED_PAD src0_sel:DWORD src1_sel:WORD_1
    v_sub_u32_sdwa v110, v110, v94 clamp dst_sel:DWORD dst_unused:UNUSED_PAD src0_sel:DWORD src1_sel:WORD_0
    v_sub_u32_sdwa v111, v111, v94 clamp dst_sel:DWORD dst_unused:UNUSED_PAD src0_sel:DWORD src1_sel:WORD_1
    v_perm_b32 v96, v96, v80, s60
    v_perm_b32 v97, v97, v80, s61
    v_perm_b32 v98, v98, v82, s60
    v_perm_b32 v99, v99, v82, s61
    v_perm_b32 v100, v100, v84, s60
    v_perm_b32 v101, v101, v84, s61
    v_perm_b32 v102, v102, v86, s60
    v_perm_b32 v103, v103, v86, s61
    v_perm_b32 v104, v104, v88, s60
    v_perm_b32 v105, v105, v88, s61
    v_perm_b32 v106, v106, v90, s60
    v_perm_b32 v107, v107, v90, s61
    v_perm_b32 v108, v108, v92, s60
    v_perm_b32 v109, v109, v92, s61
    v_perm_b32 v110, v110, v94, s60
    v_perm_b32 v111, v111, v94, s61
    ds_write2st64_b32 v15, v96, v97 offset0:128 offset1:130
    ds_write2st64_b32 v15, v98, v99 offset0:132 offset1:134
    ds_write2st64_b32 v15, v100, v101 offset0:144 offset1:146
    ds_write2st64_b32 v15, v102, v103 offset0:148 offset1:150
    ds_write2st64_b32 v15, v104, v105 offset0:160 offset1:162
    ds_write2st64_b32 v15, v106, v107 offset0:164 offset1:166
    ds_write2st64_b32 v15, v108, v109 offset0:176 offset1:178
    ds_write2st64_b32 v15, v110, v111 offset0:180 offset1:182
    s_waitcnt lgkmcnt(0)
    s_branch P_g3
P_g2:
    s_barrier
    s_nop 7
    v_mul_f32 v80, 0xbf38aa3b, v80
    v_mul_f32 v81, 0xbf38aa3b, v81
    v_mul_f32 v82, 0xbf38aa3b, v82
    v_mul_f32 v83, 0xbf38aa3b, v83
    v_mul_f32 v84, 0xbf38aa3b, v84
    v_mul_f32 v85, 0xbf38aa3b, v85
    v_mul_f32 v86, 0xbf38aa3b, v86
    v_mul_f32 v87, 0xbf38aa3b, v87
    v_mul_f32 v88, 0xbf38aa3b, v88
    v_mul_f32 v89, 0xbf38aa3b, v89
    v_mul_f32 v90, 0xbf38aa3b, v90
    v_mul_f32 v91, 0xbf38aa3b, v91
    v_mul_f32 v92, 0xbf38aa3b, v92
    v_mul_f32 v93, 0xbf38aa3b, v93
    v_mul_f32 v94, 0xbf38aa3b, v94
    v_mul_f32 v95, 0xbf38aa3b, v95
    v_add_f32 v96, 0, v96
    v_add_f32 v97, 0, v97
    v_add_f32 v98, 0, v98
    v_add_f32 v99, 0, v99
    v_add_f32 v100, 0, v100
    v_add_f32 v101, 0, v101
    v_add_f32 v102, 0, v102
    v_add_f32 v103, 0, v103
    v_add_f32 v104, 0, v104
    v_add_f32 v105, 0, v105
    v_add_f32 v106, 0, v106
    v_add_f32 v107, 0, v107
    v_add_f32 v108, 0, v108
    v_add_f32 v109, 0, v109
    v_add_f32 v110, 0, v110
    v_add_f32 v111, 0, v111
    v_add_u32 v96, 0x8000, v96
    v_add_u32 v97, 0x8000, v97
    v_add_u32 v98, 0x8000, v98
    v_add_u32 v99, 0x8000, v99
    v_add_u32 v100, 0x8000, v100
    v_add_u32 v101, 0x8000, v101
    v_add_u32 v102, 0x8000, v102
    v_add_u32 v103, 0x8000, v103
    v_add_u32 v104, 0x8000, v104
    v_add_u32 v105, 0x8000, v105
    v_add_u32 v106, 0x8000, v106
    v_add_u32 v107, 0x8000, v107
    v_add_u32 v108, 0x8000, v108
    v_add_u32 v109, 0x8000, v109
    v_add_u32 v110, 0x8000, v110
    v_add_u32 v111, 0x8000, v111
    v_cvt_pk_bf16_f32 v80, v80, v81
    v_cvt_pk_bf16_f32 v82, v82, v83
    v_cvt_pk_bf16_f32 v84, v84, v85
    v_cvt_pk_bf16_f32 v86, v86, v87
    v_cvt_pk_bf16_f32 v88, v88, v89
    v_cvt_pk_bf16_f32 v90, v90, v91
    v_cvt_pk_bf16_f32 v92, v92, v93
    v_cvt_pk_bf16_f32 v94, v94, v95
    v_sub_u32_sdwa v96, v96, v80 clamp dst_sel:DWORD dst_unused:UNUSED_PAD src0_sel:DWORD src1_sel:WORD_0
    v_sub_u32_sdwa v97, v97, v80 clamp dst_sel:DWORD dst_unused:UNUSED_PAD src0_sel:DWORD src1_sel:WORD_1
    v_sub_u32_sdwa v98, v98, v82 clamp dst_sel:DWORD dst_unused:UNUSED_PAD src0_sel:DWORD src1_sel:WORD_0
    v_sub_u32_sdwa v99, v99, v82 clamp dst_sel:DWORD dst_unused:UNUSED_PAD src0_sel:DWORD src1_sel:WORD_1
    v_sub_u32_sdwa v100, v100, v84 clamp dst_sel:DWORD dst_unused:UNUSED_PAD src0_sel:DWORD src1_sel:WORD_0
    v_sub_u32_sdwa v101, v101, v84 clamp dst_sel:DWORD dst_unused:UNUSED_PAD src0_sel:DWORD src1_sel:WORD_1
    v_sub_u32_sdwa v102, v102, v86 clamp dst_sel:DWORD dst_unused:UNUSED_PAD src0_sel:DWORD src1_sel:WORD_0
    v_sub_u32_sdwa v103, v103, v86 clamp dst_sel:DWORD dst_unused:UNUSED_PAD src0_sel:DWORD src1_sel:WORD_1
    v_sub_u32_sdwa v104, v104, v88 clamp dst_sel:DWORD dst_unused:UNUSED_PAD src0_sel:DWORD src1_sel:WORD_0
    v_sub_u32_sdwa v105, v105, v88 clamp dst_sel:DWORD dst_unused:UNUSED_PAD src0_sel:DWORD src1_sel:WORD_1
    v_sub_u32_sdwa v106, v106, v90 clamp dst_sel:DWORD dst_unused:UNUSED_PAD src0_sel:DWORD src1_sel:WORD_0
    v_sub_u32_sdwa v107, v107, v90 clamp dst_sel:DWORD dst_unused:UNUSED_PAD src0_sel:DWORD src1_sel:WORD_1
    v_sub_u32_sdwa v108, v108, v92 clamp dst_sel:DWORD dst_unused:UNUSED_PAD src0_sel:DWORD src1_sel:WORD_0
    v_sub_u32_sdwa v109, v109, v92 clamp dst_sel:DWORD dst_unused:UNUSED_PAD src0_sel:DWORD src1_sel:WORD_1
    v_sub_u32_sdwa v110, v110, v94 clamp dst_sel:DWORD dst_unused:UNUSED_PAD src0_sel:DWORD src1_sel:WORD_0
    v_sub_u32_sdwa v111, v111, v94 clamp dst_sel:DWORD dst_unused:UNUSED_PAD src0_sel:DWORD src1_sel:WORD_1
    v_perm_b32 v96, v96, v80, s60
    v_perm_b32 v97, v97, v80, s61
    v_perm_b32 v98, v98, v82, s60
    v_perm_b32 v99, v99, v82, s61
    v_perm_b32 v100, v100, v84, s60
    v_perm_b32 v101, v101, v84, s61
    v_perm_b32 v102, v102, v86, s60
    v_perm_b32 v103, v103, v86, s61
    v_perm_b32 v104, v104, v88, s60
    v_perm_b32 v105, v105, v88, s61
    v_perm_b32 v106, v106, v90, s60
    v_perm_b32 v107, v107, v90, s61
    v_perm_b32 v108, v108, v92, s60
    v_perm_b32 v109, v109, v92, s61
    v_perm_b32 v110, v110, v94, s60
    v_perm_b32 v111, v111, v94, s61
    ds_write2st64_b32 v15, v96, v97 offset0:0 offset1:2
    ds_write2st64_b32 v15, v98, v99 offset0:4 offset1:6
    ds_write2st64_b32 v15, v100, v101 offset0:16 offset1:18
    ds_write2st64_b32 v15, v102, v103 offset0:20 offset1:22
    ds_write2st64_b32 v15, v104, v105 offset0:32 offset1:34
    ds_write2st64_b32 v15, v106, v107 offset0:36 offset1:38
    ds_write2st64_b32 v15, v108, v109 offset0:48 offset1:50
    ds_write2st64_b32 v15, v110, v111 offset0:52 offset1:54
    s_waitcnt lgkmcnt(0)
    s_barrier
    ds_read_b128 v[128:131], v8 offset:0
    ds_read_b128 v[132:135], v8 offset:1024
    ds_read_b128 v[136:139], v8 offset:2048
    ds_read_b128 v[140:143], v8 offset:3072
    s_waitcnt lgkmcnt(3)
    buffer_store_dwordx4 v[128:131], v3, s[52:55], 0 offen offset:0 sc1
    s_waitcnt lgkmcnt(2)
    buffer_store_dwordx4 v[132:135], v3, s[52:55], 0 offen offset:1024 sc1
    s_waitcnt lgkmcnt(1)
    buffer_store_dwordx4 v[136:139], v3, s[52:55], 0 offen offset:2048 sc1
    s_waitcnt lgkmcnt(0)
    buffer_store_dwordx4 v[140:143], v3, s[52:55], 0 offen offset:3072 sc1
P_g3:
    s_barrier
    ds_read_b128 v[48:51], v7 offset:0
    ds_read_b128 v[52:55], v7 offset:1024
    s_waitcnt lgkmcnt(1)
    buffer_store_dwordx4 v[48:51], v5, s[52:55], 0 offen offset:0 sc1
    s_waitcnt lgkmcnt(0)
    buffer_store_dwordx4 v[52:55], v5, s[52:55], 0 offen offset:1024 sc1
    s_endpgm
P_wfrag:
    s_barrier
    s_and_b32 s47, s45, 1
    s_lshl_b32 s47, s47, 4
    v_lshl_add_u32 v80, v9, 5, v6
    v_add_u32 v80, s47, v80
    v_lshlrev_b32 v80, 4, v80
    v_lshl_add_u32 v80, v10, 10, v80
    s_and_b32 s47, s3, 2
    s_lshl_b32 s47, s47, 10
    v_add_u32 v80, s47, v80
    s_cmp_eq_u32 s46, 0
    s_cbranch_scc0 P_wf1

    v_add_u32 v81, 0x10000, v12
    ds_read_b64_tr_b16 v[92:93], v81
    ds_read_b64_tr_b16 v[94:95], v81 offset:1024
    ds_write_b128 v80, v[16:19] offset:0
    ds_write_b128 v80, v[20:23] offset:4096
    ds_write_b128 v80, v[24:27] offset:8192
    ds_write_b128 v80, v[28:31] offset:12288
    s_waitcnt lgkmcnt(4)
    v_lshlrev_b32 v84, 16, v92
    v_and_b32 v85, 0xffff0000, v92
    v_lshlrev_b32 v86, 16, v93
    v_and_b32 v87, 0xffff0000, v93
    v_lshlrev_b32 v88, 16, v94
    v_and_b32 v89, 0xffff0000, v94
    v_lshlrev_b32 v90, 16, v95
    v_and_b32 v91, 0xffff0000, v95
    v_mul_f32 v84, s59, v84
    v_mul_f32 v85, s59, v85
    v_mul_f32 v86, s59, v86
    v_mul_f32 v87, s59, v87
    v_mul_f32 v88, s59, v88
    v_mul_f32 v89, s59, v89
    v_mul_f32 v90, s59, v90
    v_mul_f32 v91, s59, v91
    v_cvt_pk_bf16_f32 v92, v84, v85
    v_cvt_pk_bf16_f32 v93, v86, v87
    v_cvt_pk_bf16_f32 v94, v88, v89
    v_cvt_pk_bf16_f32 v95, v90, v91
    ds_write_b128 v80, v[92:95] offset:32768
    s_branch P_wf2
P_wf1:
    ds_write_b128 v80, v[32:35] offset:16384
    ds_write_b128 v80, v[36:39] offset:20480
    ds_write_b128 v80, v[40:43] offset:24576
    ds_write_b128 v80, v[44:47] offset:28672
    v_lshlrev_b32 v81, 4, v2
    v_add_u32 v81, 0x188000, v81
    v_mov_b32 v96, 0x7e7f
    v_mov_b32 v97, 0x7e7f
    v_mov_b32 v98, 0x7e7f
    v_mov_b32 v99, 0x7e7f
    buffer_store_dwordx4 v[96:99], v81, s[52:55], 0 offen sc1

P_wf2:
    s_sub_u32 s47, s4, 131
    s_lshl_b32 s48, s47, 15
    s_add_u32 s48, s48, 0x1201000
    s_add_u32 s56, s30, s48
    s_addc_u32 s57, s31, 0
    s_lshl_b32 s58, s47, 12
    s_add_u32 s58, s58, 0x8000
    s_mov_b32 s59, 0x00020000
    v_lshlrev_b32 v80, 4, v0
    s_waitcnt lgkmcnt(0)
    s_barrier

    ds_read_b128 v[16:19], v80 offset:0
    ds_read_b128 v[20:23], v80 offset:8192
    ds_read_b128 v[24:27], v80 offset:16384
    ds_read_b128 v[28:31], v80 offset:24576
    ds_read_b128 v[32:35], v80 offset:32768
    s_waitcnt lgkmcnt(4)
    buffer_store_dwordx4 v[16:19], v80, s[56:59], 0 offen sc1
    v_add_u32 v80, 8192, v80
    s_waitcnt lgkmcnt(3)
    buffer_store_dwordx4 v[20:23], v80, s[56:59], 0 offen sc1
    v_add_u32 v80, 8192, v80
    s_waitcnt lgkmcnt(2)
    buffer_store_dwordx4 v[24:27], v80, s[56:59], 0 offen sc1
    v_add_u32 v80, 8192, v80
    s_waitcnt lgkmcnt(1)
    buffer_store_dwordx4 v[28:31], v80, s[56:59], 0 offen sc1
    v_add_u32 v80, 8192, v80
    s_waitcnt lgkmcnt(0)
    buffer_store_dwordx4 v[32:35], v80, s[56:59], 0 offen sc1
    v_add_u32 v80, 8192, v80
    s_endpgm
P_bin:
    v_lshlrev_b32 v3, 4, v0
    s_mul_i32 s4, s2, 12800
    v_add_u32 v64, s4, v3
    s_mov_b32 s34, 1600000
    v_add_u32 v65, 8192, v64
    s_mov_b32 s35, 0x00020000
    v_mov_b32 v4, 0
    s_mov_b32 s38, 1600000
    v_mov_b32 v5, 0
    s_mov_b32 s39, 0x00020000
    v_mov_b32 v6, 0
    v_mov_b32 v7, 0
    v_lshrrev_b32 v48, 2, v0
    v_and_b32 v49, 3, v0
    v_add_u32 v48, 1, v48
    v_lshlrev_b32 v48, 24, v48
    v_lshl_or_b32 v48, v49, 2, v48
    v_add_u32 v52, 0x80000000, v48
    v_mov_b32 v9, 4
    v_mov_b32 v10, 21400
    v_mov_b32 v11, 960
    v_cmp_gt_u32 vcc, 288, v0
    s_mov_b32 s50, -49
    s_mov_b32 s51, 144
    s_mov_b64 s[48:49], vcc
    v_cndmask_b32 v65, -2.0, v65, vcc
    s_mul_i32 s60, s6, 304
    s_sub_u32 s60, s60, 304
    v_add_u32 v70, s60, v0
    v_mul_u32_u24 v71, 21846, v70
    v_lshrrev_b32 v71, 22, v71
    s_mov_b32 s61, 1152
    v_mad_u32_u24 v70, v71, s61, v70
    s_mul_i32 s60, s5, 192
    s_sub_u32 s60, s60, 192
    v_add_u32 v70, s60, v70
    v_lshlrev_b32 v70, 7, v70
    s_mul_i32 s62, s5, s6
    s_cmp_ge_u32 s3, 5
    s_cselect_b32 s62, 0, s62
    s_cmp_lg_u32 s62, 0
    s_cselect_b32 s62, 3200000, 0
    s_mov_b32 s63, 0x00020000
    s_waitcnt lgkmcnt(0)

    s_mov_b32 s36, s14
    s_mov_b32 s37, s15
    s_mov_b32 s32, s12
    s_mov_b32 s33, s13
    s_mov_b32 s60, s8
    s_mov_b32 s61, s9
    buffer_load_dword v123, v70, s[60:63], 0 offen

    buffer_load_dwordx4 v[12:15], v64, s[36:39], 0 offen
    buffer_load_dwordx4 v[16:19], v65, s[36:39], 0 offen
    buffer_load_dwordx4 v[20:23], v64, s[32:35], 0 offen
    buffer_load_dwordx4 v[24:27], v65, s[32:35], 0 offen
    v_add_u32 v8, 0xa000, v3
    ds_write_b128 v3, v[4:7] offset:0
    ds_write_b128 v3, v[4:7] offset:8192
    ds_write_b128 v3, v[4:7] offset:16384
    ds_write_b128 v3, v[4:7] offset:24576
    ds_write_b128 v3, v[4:7] offset:32768
    s_and_b32 s53, s2, -2
    s_cmp_lg_u32 s53, 32
    s_cbranch_scc1 P_b1
    ds_write_b128 v8, v[4:7] offset:0
    ds_write_b128 v8, v[4:7] offset:8192
    ds_write_b128 v8, v[4:7] offset:16384
    ds_write_b128 v8, v[4:7] offset:24576
    ds_write_b128 v8, v[4:7] offset:32768
    v_add_u32 v64, 1164800, v64
    v_add_u32 v65, 1164800, v65
    buffer_load_dwordx4 v[80:83], v64, s[36:39], 0 offen
    buffer_load_dwordx4 v[84:87], v65, s[36:39], 0 offen
    buffer_load_dwordx4 v[88:91], v64, s[32:35], 0 offen
    buffer_load_dwordx4 v[92:95], v65, s[32:35], 0 offen
P_b1:
    v_add_u32 v49, 1, v48
    v_add_u32 v53, 1, v52
    v_add_u32 v50, 2, v48
    v_add_u32 v54, 2, v52
    v_add_u32 v51, 3, v48
    v_add_u32 v55, 3, v52
    v_mov_b32 v32, 0
    v_mov_b32 v33, 0
    v_mov_b32 v34, 0
    v_mov_b32 v35, 0
    s_add_u32 s40, s30, 0xa00000
    s_addc_u32 s41, s31, 0
    s_mov_b32 s42, 0x3ebe80
    s_mov_b32 s43, 0x20000
    s_add_u32 s44, s30, 0xe00000
    s_addc_u32 s45, s31, 0
    s_mov_b32 s46, 0x401000
    s_mov_b32 s47, 0x20000
    v_lshrrev_b32 v45, 3, v0
    v_and_b32 v46, 7, v0
    v_mul_u32_u24 v44, 128, v45
    v_mul_u32_u24 v47, 144, v45
    v_lshl_add_u32 v44, v46, 4, v44
    v_lshl_add_u32 v47, v46, 4, v47
    v_mov_b32 v45, 37888
    v_mov_b32 v66, 36864
    v_mov_b32 v67, 0
    s_mov_b32 s52, 40960
    s_waitcnt lgkmcnt(0)
    s_barrier

    s_waitcnt vmcnt(3)
    v_mul_u32_u24 v36, v12, v10
    v_mul_u32_u24 v37, v13, v10
    v_mul_u32_u24 v38, v14, v10
    v_mul_u32_u24 v39, v15, v10
    v_lshrrev_b32 v36, 20, v36
    v_lshrrev_b32 v37, 20, v37
    v_lshrrev_b32 v38, 20, v38
    v_lshrrev_b32 v39, 20, v39
    v_lshl_add_u32 v56, v36, 2, v66
    v_lshl_add_u32 v57, v37, 2, v66
    v_lshl_add_u32 v58, v38, 2, v66
    v_lshl_add_u32 v59, v39, 2, v66
    ds_add_rtn_u32 v28, v56, v9
    ds_add_rtn_u32 v29, v57, v9
    ds_add_rtn_u32 v30, v58, v9
    ds_add_rtn_u32 v31, v59, v9
    s_waitcnt vmcnt(2)
    s_mov_b64 exec, s[48:49]
    s_cbranch_execz P_q867
    v_mul_u32_u24 v40, v16, v10
    v_mul_u32_u24 v41, v17, v10
    v_mul_u32_u24 v42, v18, v10
    v_mul_u32_u24 v43, v19, v10
    v_lshrrev_b32 v40, 20, v40
    v_lshrrev_b32 v41, 20, v41
    v_lshrrev_b32 v42, 20, v42
    v_lshrrev_b32 v43, 20, v43
    v_lshl_add_u32 v60, v40, 2, v66
    v_lshl_add_u32 v61, v41, 2, v66
    v_lshl_add_u32 v62, v42, 2, v66
    v_lshl_add_u32 v63, v43, 2, v66
    ds_add_rtn_u32 v32, v60, v9
    ds_add_rtn_u32 v33, v61, v9
    ds_add_rtn_u32 v34, v62, v9
    ds_add_rtn_u32 v35, v63, v9
P_q867:
    s_mov_b64 exec, -1
    s_waitcnt vmcnt(1)
    v_mad_i32_i24 v12, v36, s50, v12
    v_mul_u32_u24 v56, v20, v10
    v_mul_u32_u24 v12, 65, v12
    v_lshrrev_b32 v56, 26, v56
    v_bfe_u32 v12, v12, 2, 6
    v_mad_u32_u24 v20, v56, v11, v20
    v_lshl_or_b32 v12, v12, 18, v48
    v_mad_u32_u24 v56, v36, s51, v67
    v_lshl_or_b32 v20, v20, 4, v12
    v_mad_i32_i24 v13, v37, s50, v13
    v_mul_u32_u24 v57, v21, v10
    v_mul_u32_u24 v13, 65, v13
    v_lshrrev_b32 v57, 26, v57
    v_bfe_u32 v13, v13, 2, 6
    v_mad_u32_u24 v21, v57, v11, v21
    v_lshl_or_b32 v13, v13, 18, v49
    v_mad_u32_u24 v57, v37, s51, v67
    v_lshl_or_b32 v21, v21, 4, v13
    v_mad_i32_i24 v14, v38, s50, v14
    v_mul_u32_u24 v58, v22, v10
    v_mul_u32_u24 v14, 65, v14
    v_lshrrev_b32 v58, 26, v58
    v_bfe_u32 v14, v14, 2, 6
    v_mad_u32_u24 v22, v58, v11, v22
    v_lshl_or_b32 v14, v14, 18, v50
    v_mad_u32_u24 v58, v38, s51, v67
    v_lshl_or_b32 v22, v22, 4, v14
    v_mad_i32_i24 v15, v39, s50, v15
    v_mul_u32_u24 v59, v23, v10
    v_mul_u32_u24 v15, 65, v15
    v_lshrrev_b32 v59, 26, v59
    v_bfe_u32 v15, v15, 2, 6
    v_mad_u32_u24 v23, v59, v11, v23
    v_lshl_or_b32 v15, v15, 18, v51
    v_mad_u32_u24 v59, v39, s51, v67
    v_lshl_or_b32 v23, v23, 4, v15
    s_waitcnt vmcnt(0)
    s_mov_b64 exec, s[48:49]
    s_cbranch_execz P_q925
    v_mad_i32_i24 v16, v40, s50, v16
    v_mul_u32_u24 v60, v24, v10
    v_mul_u32_u24 v16, 65, v16
    v_lshrrev_b32 v60, 26, v60
    v_bfe_u32 v16, v16, 2, 6
    v_mad_u32_u24 v24, v60, v11, v24
    v_lshl_or_b32 v16, v16, 18, v52
    v_mad_u32_u24 v60, v40, s51, v67
    v_lshl_or_b32 v24, v24, 4, v16
    v_mad_i32_i24 v17, v41, s50, v17
    v_mul_u32_u24 v61, v25, v10
    v_mul_u32_u24 v17, 65, v17
    v_lshrrev_b32 v61, 26, v61
    v_bfe_u32 v17, v17, 2, 6
    v_mad_u32_u24 v25, v61, v11, v25
    v_lshl_or_b32 v17, v17, 18, v53
    v_mad_u32_u24 v61, v41, s51, v67
    v_lshl_or_b32 v25, v25, 4, v17
    v_mad_i32_i24 v18, v42, s50, v18
    v_mul_u32_u24 v62, v26, v10
    v_mul_u32_u24 v18, 65, v18
    v_lshrrev_b32 v62, 26, v62
    v_bfe_u32 v18, v18, 2, 6
    v_mad_u32_u24 v26, v62, v11, v26
    v_lshl_or_b32 v18, v18, 18, v54
    v_mad_u32_u24 v62, v42, s51, v67
    v_lshl_or_b32 v26, v26, 4, v18
    v_mad_i32_i24 v19, v43, s50, v19
    v_mul_u32_u24 v63, v27, v10
    v_mul_u32_u24 v19, 65, v19
    v_lshrrev_b32 v63, 26, v63
    v_bfe_u32 v19, v19, 2, 6
    v_mad_u32_u24 v27, v63, v11, v27
    v_lshl_or_b32 v19, v19, 18, v55
    v_mad_u32_u24 v63, v43, s51, v67
    v_lshl_or_b32 v27, v27, 4, v19
P_q925:
    s_mov_b64 exec, -1
P_chunk1:
    s_mul_i32 s54, s2, 32896
    s_add_u32 s55, s54, 8192
    s_add_u32 s56, s55, 8192
    s_add_u32 s57, s56, 8192
    s_waitcnt lgkmcnt(0)
    v_max3_u32 v46, v28, v29, v30
    v_max3_u32 v46, v46, v31, v32
    v_max3_u32 v46, v46, v33, v34
    v_max_u32 v46, v46, v35
    v_cmp_lt_u32 vcc, 124, v46
    s_cbranch_vccnz P_ovf

    v_add_u32 v56, v56, v28
    v_add_u32 v57, v57, v29
    v_add_u32 v58, v58, v30
    v_add_u32 v59, v59, v31
    ds_write_b32 v56, v20
    ds_write_b32 v57, v21
    ds_write_b32 v58, v22
    ds_write_b32 v59, v23
    s_mov_b64 exec, s[48:49]
    s_cbranch_execz P_q986
    v_add_u32 v60, v60, v32
    v_add_u32 v61, v61, v33
    v_add_u32 v62, v62, v34
    v_add_u32 v63, v63, v35
    ds_write_b32 v60, v24
    ds_write_b32 v61, v25
    ds_write_b32 v62, v26
    ds_write_b32 v63, v27
P_q986:
    s_mov_b64 exec, -1
P_noovf:
    s_waitcnt lgkmcnt(0)
    s_barrier
    ds_read_b128 v[12:15], v47 offset:0
    ds_read_b128 v[16:19], v47 offset:9216
    ds_read_b128 v[20:23], v47 offset:18432
    ds_read_b128 v[24:27], v47 offset:27648
    ds_read_b32 v46, v45
    s_cmp_ge_u32 s2, 123
    s_cbranch_scc0 P_o1
    s_waitcnt lgkmcnt(0)
    buffer_store_dwordx4 v[12:15], v44, s[40:43], s54 offen
    buffer_store_dwordx4 v[16:19], v44, s[40:43], s55 offen
    buffer_store_dwordx4 v[20:23], v44, s[40:43], s56 offen
    buffer_store_dwordx4 v[24:27], v44, s[40:43], s57 offen
    s_branch P_o2
P_o1:
    s_waitcnt lgkmcnt(4)
    buffer_store_dwordx4 v[12:15], v44, s[40:43], s54 offen sc1
    s_waitcnt lgkmcnt(3)
    buffer_store_dwordx4 v[16:19], v44, s[40:43], s55 offen sc1
    s_waitcnt lgkmcnt(2)
    buffer_store_dwordx4 v[20:23], v44, s[40:43], s56 offen sc1
    s_waitcnt lgkmcnt(1)
    buffer_store_dwordx4 v[24:27], v44, s[40:43], s57 offen sc1
P_o2:
    s_lshl_b32 s54, s2, 2
    v_cmp_eq_u32 vcc, 256, v0
    v_mov_b32 v69, s54
    s_waitcnt lgkmcnt(0)
    v_lshrrev_b32 v46, 2, v46
    v_cndmask_b32 v69, -2.0, v69, vcc
    buffer_store_dword v46, v69, s[44:47], 0 offen

    v_add_u32 v66, s52, v66
    v_add_u32 v67, s52, v67
    v_add_u32 v45, s52, v45
    v_add_u32 v47, s52, v47
    s_add_u32 s2, s2, 91
    s_cmp_eq_u32 s53, 32
    s_mov_b32 s53, 0
    s_cbranch_scc1 P_chunk

P_end:
    s_endpgm
P_chunk:
    s_waitcnt vmcnt(5)
    v_mov_b64 v[12:13], v[80:81]
    v_mov_b64 v[14:15], v[82:83]
    v_mov_b64 v[16:17], v[84:85]
    v_mov_b64 v[18:19], v[86:87]
    v_mov_b64 v[20:21], v[88:89]
    v_mov_b64 v[22:23], v[90:91]
    v_mov_b64 v[24:25], v[92:93]
    v_mov_b64 v[26:27], v[94:95]
    v_mul_u32_u24 v36, v12, v10
    v_mul_u32_u24 v37, v13, v10
    v_mul_u32_u24 v38, v14, v10
    v_mul_u32_u24 v39, v15, v10
    v_lshrrev_b32 v36, 20, v36
    v_lshrrev_b32 v37, 20, v37
    v_lshrrev_b32 v38, 20, v38
    v_lshrrev_b32 v39, 20, v39
    v_lshl_add_u32 v56, v36, 2, v66
    v_lshl_add_u32 v57, v37, 2, v66
    v_lshl_add_u32 v58, v38, 2, v66
    v_lshl_add_u32 v59, v39, 2, v66
    ds_add_rtn_u32 v28, v56, v9
    ds_add_rtn_u32 v29, v57, v9
    ds_add_rtn_u32 v30, v58, v9
    ds_add_rtn_u32 v31, v59, v9
    s_mov_b64 exec, s[48:49]
    s_cbranch_execz P_q1070
    v_mul_u32_u24 v40, v16, v10
    v_mul_u32_u24 v41, v17, v10
    v_mul_u32_u24 v42, v18, v10
    v_mul_u32_u24 v43, v19, v10
    v_lshrrev_b32 v40, 20, v40
    v_lshrrev_b32 v41, 20, v41
    v_lshrrev_b32 v42, 20, v42
    v_lshrrev_b32 v43, 20, v43
    v_lshl_add_u32 v60, v40, 2, v66
    v_lshl_add_u32 v61, v41, 2, v66
    v_lshl_add_u32 v62, v42, 2, v66
    v_lshl_add_u32 v63, v43, 2, v66
    ds_add_rtn_u32 v32, v60, v9
    ds_add_rtn_u32 v33, v61, v9
    ds_add_rtn_u32 v34, v62, v9
    ds_add_rtn_u32 v35, v63, v9
P_q1070:
    s_mov_b64 exec, -1
    v_mad_i32_i24 v12, v36, s50, v12
    v_mul_u32_u24 v56, v20, v10
    v_mul_u32_u24 v12, 65, v12
    v_lshrrev_b32 v56, 26, v56
    v_bfe_u32 v12, v12, 2, 6
    v_mad_u32_u24 v20, v56, v11, v20
    v_lshl_or_b32 v12, v12, 18, v48
    v_mad_u32_u24 v56, v36, s51, v67
    v_lshl_or_b32 v20, v20, 4, v12
    v_mad_i32_i24 v13, v37, s50, v13
    v_mul_u32_u24 v57, v21, v10
    v_mul_u32_u24 v13, 65, v13
    v_lshrrev_b32 v57, 26, v57
    v_bfe_u32 v13, v13, 2, 6
    v_mad_u32_u24 v21, v57, v11, v21
    v_lshl_or_b32 v13, v13, 18, v49
    v_mad_u32_u24 v57, v37, s51, v67
    v_lshl_or_b32 v21, v21, 4, v13
    v_mad_i32_i24 v14, v38, s50, v14
    v_mul_u32_u24 v58, v22, v10
    v_mul_u32_u24 v14, 65, v14
    v_lshrrev_b32 v58, 26, v58
    v_bfe_u32 v14, v14, 2, 6
    v_mad_u32_u24 v22, v58, v11, v22
    v_lshl_or_b32 v14, v14, 18, v50
    v_mad_u32_u24 v58, v38, s51, v67
    v_lshl_or_b32 v22, v22, 4, v14
    v_mad_i32_i24 v15, v39, s50, v15
    v_mul_u32_u24 v59, v23, v10
    v_mul_u32_u24 v15, 65, v15
    v_lshrrev_b32 v59, 26, v59
    v_bfe_u32 v15, v15, 2, 6
    v_mad_u32_u24 v23, v59, v11, v23
    v_lshl_or_b32 v15, v15, 18, v51
    v_mad_u32_u24 v59, v39, s51, v67
    v_lshl_or_b32 v23, v23, 4, v15
    s_mov_b64 exec, s[48:49]
    s_cbranch_execz P_q1126
    v_mad_i32_i24 v16, v40, s50, v16
    v_mul_u32_u24 v60, v24, v10
    v_mul_u32_u24 v16, 65, v16
    v_lshrrev_b32 v60, 26, v60
    v_bfe_u32 v16, v16, 2, 6
    v_mad_u32_u24 v24, v60, v11, v24
    v_lshl_or_b32 v16, v16, 18, v52
    v_mad_u32_u24 v60, v40, s51, v67
    v_lshl_or_b32 v24, v24, 4, v16
    v_mad_i32_i24 v17, v41, s50, v17
    v_mul_u32_u24 v61, v25, v10
    v_mul_u32_u24 v17, 65, v17
    v_lshrrev_b32 v61, 26, v61
    v_bfe_u32 v17, v17, 2, 6
    v_mad_u32_u24 v25, v61, v11, v25
    v_lshl_or_b32 v17, v17, 18, v53
    v_mad_u32_u24 v61, v41, s51, v67
    v_lshl_or_b32 v25, v25, 4, v17
    v_mad_i32_i24 v18, v42, s50, v18
    v_mul_u32_u24 v62, v26, v10
    v_mul_u32_u24 v18, 65, v18
    v_lshrrev_b32 v62, 26, v62
    v_bfe_u32 v18, v18, 2, 6
    v_mad_u32_u24 v26, v62, v11, v26
    v_lshl_or_b32 v18, v18, 18, v54
    v_mad_u32_u24 v62, v42, s51, v67
    v_lshl_or_b32 v26, v26, 4, v18
    v_mad_i32_i24 v19, v43, s50, v19
    v_mul_u32_u24 v63, v27, v10
    v_mul_u32_u24 v19, 65, v19
    v_lshrrev_b32 v63, 26, v63
    v_bfe_u32 v19, v19, 2, 6
    v_mad_u32_u24 v27, v63, v11, v27
    v_lshl_or_b32 v19, v19, 18, v55
    v_mad_u32_u24 v63, v43, s51, v67
    v_lshl_or_b32 v27, v27, 4, v19
P_q1126:
    s_mov_b64 exec, -1
    s_branch P_chunk1
P_ovf:
    v_add_u32 v56, v56, v28
    v_add_u32 v57, v57, v29
    v_add_u32 v58, v58, v30
    v_add_u32 v59, v59, v31
    v_add_u32 v60, v60, v32
    v_add_u32 v61, v61, v33
    v_add_u32 v62, v62, v34
    v_add_u32 v63, v63, v35
    s_mov_b64 exec, -1
    v_cmp_ge_u32 vcc, 124, v28
    s_and_b64 exec, exec, vcc
    ds_write_b32 v56, v20
    s_mov_b64 exec, -1
    v_cmp_ge_u32 vcc, 124, v29
    s_and_b64 exec, exec, vcc
    ds_write_b32 v57, v21
    s_mov_b64 exec, -1
    v_cmp_ge_u32 vcc, 124, v30
    s_and_b64 exec, exec, vcc
    ds_write_b32 v58, v22
    s_mov_b64 exec, -1
    v_cmp_ge_u32 vcc, 124, v31
    s_and_b64 exec, exec, vcc
    ds_write_b32 v59, v23
    s_mov_b64 exec, s[48:49]
    v_cmp_ge_u32 vcc, 124, v32
    s_and_b64 exec, exec, vcc
    ds_write_b32 v60, v24
    s_mov_b64 exec, s[48:49]
    v_cmp_ge_u32 vcc, 124, v33
    s_and_b64 exec, exec, vcc
    ds_write_b32 v61, v25
    s_mov_b64 exec, s[48:49]
    v_cmp_ge_u32 vcc, 124, v34
    s_and_b64 exec, exec, vcc
    ds_write_b32 v62, v26
    s_mov_b64 exec, s[48:49]
    v_cmp_ge_u32 vcc, 124, v35
    s_and_b64 exec, exec, vcc
    ds_write_b32 v63, v27
    s_mov_b64 exec, -1
    s_mul_i32 s58, s2, 12800
    s_add_u32 s58, s58, 0x1000
    s_add_u32 s59, s58, 0x200000
    v_mov_b32 v46, 0
    s_mov_b64 exec, -1
    v_cmp_lt_u32 vcc, 124, v28
    s_and_b64 exec, exec, vcc
    s_cbranch_execz P_ov0
    ds_add_rtn_u32 v46, v45, v9
    s_waitcnt lgkmcnt(0)
    buffer_store_dword v20, v46, s[44:47], s58 offen
    buffer_store_dword v36, v46, s[44:47], s59 offen
P_ov0:
    s_mov_b64 exec, -1
    v_cmp_lt_u32 vcc, 124, v29
    s_and_b64 exec, exec, vcc
    s_cbranch_execz P_ov1
    ds_add_rtn_u32 v46, v45, v9
    s_waitcnt lgkmcnt(0)
    buffer_store_dword v21, v46, s[44:47], s58 offen
    buffer_store_dword v37, v46, s[44:47], s59 offen
P_ov1:
    s_mov_b64 exec, -1
    v_cmp_lt_u32 vcc, 124, v30
    s_and_b64 exec, exec, vcc
    s_cbranch_execz P_ov2
    ds_add_rtn_u32 v46, v45, v9
    s_waitcnt lgkmcnt(0)
    buffer_store_dword v22, v46, s[44:47], s58 offen
    buffer_store_dword v38, v46, s[44:47], s59 offen
P_ov2:
    s_mov_b64 exec, -1
    v_cmp_lt_u32 vcc, 124, v31
    s_and_b64 exec, exec, vcc
    s_cbranch_execz P_ov3
    ds_add_rtn_u32 v46, v45, v9
    s_waitcnt lgkmcnt(0)
    buffer_store_dword v23, v46, s[44:47], s58 offen
    buffer_store_dword v39, v46, s[44:47], s59 offen
P_ov3:
    s_mov_b64 exec, s[48:49]
    v_cmp_lt_u32 vcc, 124, v32
    s_and_b64 exec, exec, vcc
    s_cbranch_execz P_ov4
    ds_add_rtn_u32 v46, v45, v9
    s_waitcnt lgkmcnt(0)
    buffer_store_dword v24, v46, s[44:47], s58 offen
    buffer_store_dword v40, v46, s[44:47], s59 offen
P_ov4:
    s_mov_b64 exec, s[48:49]
    v_cmp_lt_u32 vcc, 124, v33
    s_and_b64 exec, exec, vcc
    s_cbranch_execz P_ov5
    ds_add_rtn_u32 v46, v45, v9
    s_waitcnt lgkmcnt(0)
    buffer_store_dword v25, v46, s[44:47], s58 offen
    buffer_store_dword v41, v46, s[44:47], s59 offen
P_ov5:
    s_mov_b64 exec, s[48:49]
    v_cmp_lt_u32 vcc, 124, v34
    s_and_b64 exec, exec, vcc
    s_cbranch_execz P_ov6
    ds_add_rtn_u32 v46, v45, v9
    s_waitcnt lgkmcnt(0)
    buffer_store_dword v26, v46, s[44:47], s58 offen
    buffer_store_dword v42, v46, s[44:47], s59 offen
P_ov6:
    s_mov_b64 exec, s[48:49]
    v_cmp_lt_u32 vcc, 124, v35
    s_and_b64 exec, exec, vcc
    s_cbranch_execz P_ov7
    ds_add_rtn_u32 v46, v45, v9
    s_waitcnt lgkmcnt(0)
    buffer_store_dword v27, v46, s[44:47], s58 offen
    buffer_store_dword v43, v46, s[44:47], s59 offen
P_ov7:
    s_mov_b64 exec, -1
    s_branch P_noovf
.globl edge_kernel
.p2align 8
.type edge_kernel,@function
edge_kernel:
    s_cmp_ge_u32 s2, 256
    s_cbranch_scc1 E_end
    s_load_dwordx2 s[30:31], s[0:1], 88
    s_load_dwordx4 s[8:11], s[0:1], 0
    s_load_dwordx2 s[26:27], s[0:1], 72
    v_mov_b32 v209, v0
    v_lshrrev_b32 v1, 6, v0
    s_mov_b32 s25, 0
    v_readfirstlane_b32 s3, v1
    s_mov_b32 s6, 0
    s_mov_b32 s7, -1
    s_mov_b32 s24, 16
    s_mov_b32 s99, 0
    s_mov_b32 s22, 6400
    s_lshr_b32 s4, s3, 1
    s_and_b32 s5, s3, 1

E_round:
    v_and_b32 v32, 63, v209
    s_mul_i32 s33, s4, 2304
    v_lshlrev_b32 v166, 4, v209
    s_add_u32 s34, s33, 5120
    v_lshrrev_b32 v160, 4, v32
    s_lshl_b32 s35, s5, 7
    v_lshlrev_b32 v165, 4, v32
    s_add_u32 s35, s35, s33
    v_lshrrev_b32 v33, 5, v32
    s_add_u32 s35, s35, 14592
    v_and_b32 v35, 1, v32
    s_lshl_b32 s20, s4, 13
    v_xor_b32 v35, v35, v33
    s_add_u32 s20, s20, 65536
    v_lshlrev_b32 v35, 4, v35
    s_lshl_b32 s33, s33, 2
    v_add_u32 v206, -512, v35
    s_add_u32 s33, s33, 23808
    v_lshlrev_b32 v38, 4, v33
    v_add_u32 v204, s34, v38
    v_lshrrev_b32 v35, 1, v32
    v_lshl_add_u32 v205, v35, 2, s35
    v_mov_b32 v148, 0
    v_mov_b32 v149, 0
    v_mov_b32 v150, 0
    v_mov_b32 v151, 0
    v_and_b32 v186, 31, v32
    v_and_b32 v193, 3, v32
    v_and_b32 v187, 30, v32
    v_add_u32 v187, v187, v33
    v_lshl_add_u32 v201, v187, 4, s33
    v_and_b32 v187, 40, v32
    v_and_b32 v188, 8, v32
    v_add_u32 v187, v187, v188
    v_and_b32 v188, 4, v32
    v_add_u32 v187, v187, v188
    v_bfe_u32 v188, v32, 1, 1
    v_add_u32 v187, v187, v188
    v_and_b32 v188, 1, v32
    v_lshl_add_u32 v187, v188, 1, v187
    v_lshl_add_u32 v202, v187, 3, s33
    v_and_b32 v188, 1, v160
    v_add_u32 v188, -1, v188
    v_and_b32 v188, 0x5555, v188
    v_or_b32 v203, 0x88888888, v188
    v_lshrrev_b32 v190, 4, v186
    v_xor_b32 v190, v190, v33
    v_add_u32 v187, v186, v186
    v_add_u32 v190, v190, v187
    v_lshl_add_u32 v200, v190, 4, s20

    v_mov_b32 v161, 10923
    s_mul_i32 s33, s2, 128
    v_add_u32 v162, 512, v209
    s_add_u32 s33, s33, 0xa00000
    v_mul_u32_u24 v144, v209, v161
    s_mov_b32 s38, 4079232
    v_mul_u32_u24 v145, v162, v161
    s_mov_b32 s39, 0x00020000
    v_lshrrev_b32 v144, 16, v144
    s_mov_b32 s34, 32800
    v_lshrrev_b32 v145, 16, v145
    v_mad_u32_u24 v168, v144, s34, v166
    v_mad_u32_u24 v169, v145, s34, v166
    v_add_u32 v169, 8192, v169
    s_cmp_lt_u32 s3, 4
    s_cbranch_scc1 E_b3
    v_bfe_u32 v145, v209, 1, 7
    v_mul_u32_u24 v169, 32864, v145
    v_add_u32 v169, v169, v166
    v_add_u32 v169, -4000, v169

E_b3:
    s_cmp_lg_u32 s6, 0
    s_cbranch_scc1 E_b0
    s_waitcnt lgkmcnt(0)
    s_add_u32 s36, s30, s33
    s_addc_u32 s37, s31, 0

    buffer_load_dwordx4 v[64:67], v168, s[36:39], 0 offen
    buffer_load_dwordx4 v[68:71], v169, s[36:39], 0 offen
E_b0:
    s_cmp_ge_u32 s3, 3
    s_cbranch_scc1 E_b1
    ds_write_b128 v166, v[148:151]
    s_waitcnt lgkmcnt(0)

E_b1:
    s_barrier
    v_mov_b32 v152, 0xc400
    s_mov_b32 s44, s8
    v_mov_b32 v153, 0xc400
    s_mov_b32 s45, s9
    v_mov_b32 v154, 0xc400
    s_mov_b32 s46, 0x30d400
    v_mov_b32 v155, 0xc400
    s_mov_b32 s47, 0x20000
    v_mov_b32 v156, 0x3ff0
    s_mul_i32 s32, s2, 49
    v_mov_b32 v157, 0x3ff0
    s_lshl_b32 s33, s3, 3
    v_mov_b32 v158, 0x3ff0
    s_add_u32 s33, s33, s32
    v_mov_b32 v159, 0x3ff0
    s_lshl_b32 s34, s3, 1
    v_and_b32 v161, 15, v32
    s_lshl_b32 s35, s3, 11
    v_add_u32 v162, s33, v160
    s_add_u32 s35, s35, 98304
    v_lshlrev_b32 v162, 8, v162
    s_mov_b32 m0, s35
    v_xor_b32 v163, s34, v161
    s_cmp_ge_u32 s3, 6
    s_cselect_b32 s33, 0x40000010, 16
    s_cmp_ge_u32 s3, 7
    s_cselect_b32 s32, 0x40000000, 0
    v_lshl_add_u32 v163, v163, 4, v162
    v_xor_b32 v164, s33, v163
    v_or_b32 v163, s32, v163
    s_and_b32 s33, s3, 3
    s_lshl_b32 s33, s33, 10
    s_lshr_b32 s34, s3, 2
    s_lshl_b32 s34, s34, 15
    s_add_u32 s33, s33, s34
    s_add_u32 s33, s33, 0x1201000
    buffer_load_dwordx4 v163, s[44:47], 0 offen lds
    buffer_load_dwordx4 v164, s[44:47], 0 offen offset:1024 lds
    s_add_u32 s48, s30, s33
    s_addc_u32 s49, s31, 0
    s_mov_b32 s50, 0x7400
    s_mov_b32 s51, 0x00020000

    ds_write_b128 v166, v[148:151] offset:23808
    ds_write_b128 v166, v[148:151] offset:32000
    ds_write_b128 v166, v[148:151] offset:40192
    ds_write_b128 v166, v[148:151] offset:48384
    ds_write_b128 v166, v[148:151] offset:52480
    ds_write_b128 v166, v[152:155] offset:5120
    ds_write_b128 v166, v[156:159] offset:14592
    s_cmp_lt_u32 s3, 6
    s_cbranch_scc1 E_i1
    ds_write_b128 v166, v[152:155] offset:6400
    ds_write_b128 v166, v[156:159] offset:15616

E_i1:
    s_mov_b32 s29, 0
    buffer_load_dwordx4 v[216:219], v165, s[48:51], s29 offen
    s_mov_b32 s29, 4096
    buffer_load_dwordx4 v[220:223], v165, s[48:51], s29 offen
    v_mov_b32 v40, 16
    s_mov_b32 s56, s10
    v_mov_b32 v41, 0x3f80
    s_mov_b32 s57, s11
    v_mov_b32 v43, 0xff00000f
    s_mov_b32 s58, 0xc35000
    v_lshlrev_b32 v44, 5, v32
    s_mov_b32 s59, 0x20000
    v_mul_u32_u24 v45, 9216, v160
    s_lshl_b32 s35, s4, 10
    v_mov_b32 v42, s25
    s_add_u32 s35, s35, 0x1211000
    v_mad_u32_u24 v144, v144, s24, v42
    s_add_u32 s40, s30, s35
    v_mad_u32_u24 v145, v145, s24, v42
    s_addc_u32 s41, s31, 0
    v_mov_b32 v47, 2080
    s_mov_b32 s42, 0x400
    v_and_b32 v192, 1, v160
    s_mov_b32 s43, 0x00020000
    v_lshrrev_b32 v194, 1, v32
    s_lshl_b32 s35, s5, 8
    v_add_u32 v195, v32, v32
    s_add_u32 s35, s35, 4096
    v_and_b32 v194, 4, v194
    s_add_u32 s52, s30, s35
    v_and_b32 v195, 8, v195
    s_addc_u32 s53, s31, 0
    v_or3_b32 v194, v193, v194, v195
    s_mov_b32 s54, 0x800000
    v_lshl_add_u32 v192, v194, 2, v192
    s_or_b32 s53, s53, 0x80000000
    v_xor_b32 v194, v194, v33
    s_mov_b32 s55, 0x00c00000
    v_lshl_add_u32 v192, v192, 4, v194
    v_lshlrev_b32 v192, 4, v192
    v_add_u32 v136, 98304, v192
    s_lshl_b32 s33, s4, 3
    s_add_u32 s33, s33, 2048
    v_mov_b32 v215, s33
    s_lshl_b32 s33, s3, 2
    s_add_u32 s33, s33, 2048
    v_mov_b32 v248, s33
    v_mov_b32 v212, 1
    s_lshl_b32 s33, s5, 1
    v_mov_b32 v255, s33
    v_xor_b32 v254, 2, v255
    s_add_u32 s33, s5, 1
    v_mov_b32 v213, s33
    v_mov_b32 v249, 0x1fff
    s_mul_i32 s33, s2, 49
    s_add_u32 s33, s33, s4
    s_lshl_b32 s33, s33, 8
    s_lshl_b32 s34, s5, 7
    s_add_u32 s33, s33, s34
    v_lshlrev_b32 v250, 13, v33
    v_lshl_add_u32 v250, v186, 2, v250
    v_add_u32 v250, s33, v250
    v_add_u32 v252, 4096, v250
    v_lshrrev_b32 v189, 3, v32
    v_xor_b32 v189, v189, v33
    v_and_b32 v189, 1, v189
    v_add_u32 v189, -1, v189
    v_and_b32 v191, 1, v32
    v_lshlrev_b32 v191, 4, v191
    v_and_b32 v189, 0x80, v189
    v_lshlrev_b32 v189, v191, v189
    v_bfe_u32 v191, v32, 1, 2
    v_lshrrev_b32 v192, 2, v32
    v_and_b32 v192, 4, v192
    v_add_u32 v191, v191, v192
    v_lshlrev_b32 v189, v191, v189
    v_lshlrev_b32 v128, 7, v189
    v_lshlrev_b32 v129, 6, v189
    v_lshlrev_b32 v130, 5, v189
    v_lshlrev_b32 v131, 4, v189
    v_lshlrev_b32 v132, 3, v189
    v_lshlrev_b32 v133, 2, v189
    v_lshlrev_b32 v134, 1, v189
    v_lshlrev_b32 v135, 0, v189
    v_and_b32 v128, 0x40004000, v128
    v_and_b32 v129, 0x40004000, v129
    v_and_b32 v130, 0x40004000, v130
    v_and_b32 v131, 0x40004000, v131
    v_and_b32 v132, 0x40004000, v132
    v_and_b32 v133, 0x40004000, v133
    v_and_b32 v134, 0x40004000, v134
    v_and_b32 v135, 0x40004000, v135
    s_and_b32 s33, s3, 3
    s_lshr_b32 s34, s3, 2
    s_add_u32 s34, s34, 10
    s_lshl_b32 s33, s33, s34
    s_mov_b32 s34, 131072
    s_cmp_lt_u32 s3, 4
    s_cselect_b32 s34, 114688, s34
    s_add_u32 s33, s33, s34
    v_add_u32 v137, s33, v165
    s_lshl_b32 s33, s3, 11
    s_add_u32 s33, s33, 114688
    v_add_u32 v138, s33, v165
    s_lshl_b32 s21, s5, 10
    s_add_u32 s33, s20, s21
    s_mov_b32 m0, s33

    s_waitcnt vmcnt(5)
    v_cmp_ne_u32 s[64:65], 0, v64
    v_lshrrev_b32 v80, 13, v64
    v_and_b32 v80, 0x7f8, v80
    v_cmp_ne_u32 s[66:67], 0, v65
    v_lshrrev_b32 v81, 13, v65
    v_and_b32 v81, 0x7f8, v81
    v_cmp_ne_u32 s[68:69], 0, v66
    v_lshrrev_b32 v82, 13, v66
    v_and_b32 v82, 0x7f8, v82
    v_cmp_ne_u32 s[70:71], 0, v67
    v_lshrrev_b32 v83, 13, v67
    v_and_b32 v83, 0x7f8, v83
    s_mov_b64 exec, s[64:65]
    ds_add_rtn_u32 v72, v80, v40
    s_mov_b64 exec, s[66:67]
    ds_add_rtn_u32 v73, v81, v40
    s_mov_b64 exec, s[68:69]
    ds_add_rtn_u32 v74, v82, v40
    s_mov_b64 exec, s[70:71]
    ds_add_rtn_u32 v75, v83, v40
    s_mov_b64 exec, -1
    s_waitcnt vmcnt(4)
    v_or3_b32 v34, v68, v69, v70
    v_or_b32 v34, v34, v71
    v_cmp_ne_u32 s[28:29], 0, v34
    s_or_b32 s28, s28, s29

    s_cmp_eq_u32 s28, 0
    s_cbranch_scc1 E_sk1
    v_cmp_ne_u32 s[72:73], 0, v68
    v_lshrrev_b32 v84, 13, v68
    v_and_b32 v84, 0x7f8, v84
    v_cmp_ne_u32 s[74:75], 0, v69
    v_lshrrev_b32 v85, 13, v69
    v_and_b32 v85, 0x7f8, v85
    v_cmp_ne_u32 s[76:77], 0, v70
    v_lshrrev_b32 v86, 13, v70
    v_and_b32 v86, 0x7f8, v86
    v_cmp_ne_u32 s[78:79], 0, v71
    v_lshrrev_b32 v87, 13, v71
    v_and_b32 v87, 0x7f8, v87
    s_mov_b64 exec, s[72:73]
    ds_add_rtn_u32 v76, v84, v40
    s_mov_b64 exec, s[74:75]
    ds_add_rtn_u32 v77, v85, v40
    s_mov_b64 exec, s[76:77]
    ds_add_rtn_u32 v78, v86, v40
    s_mov_b64 exec, s[78:79]
    ds_add_rtn_u32 v79, v87, v40
    s_cmp_ge_u32 s3, 4
    s_cselect_b32 s32, 0xaaaaaaaa, 0
    s_mov_b32 s33, s32
    s_and_b64 exec, s[78:79], s[32:33]
    s_cbranch_execz E_nofull
    ds_write_b32 v47, v40
    s_lshl_b32 s32, s3, 3
    v_mov_b32 v36, exec_lo
    v_mov_b32 v37, exec_hi
    v_mov_b32 v35, s32
    ds_write_b64 v35, v[36:37] offset:2080
E_nofull:
    s_mov_b64 exec, -1
E_sk1:
    s_mov_b32 s29, 8192
    buffer_load_dwordx4 v[224:227], v165, s[48:51], s29 offen
    v_lshrrev_b32 v104, 17, v64
    v_and_b32 v88, 0x3fff0, v64
    v_and_or_b32 v96, v64, v43, v144
    v_lshrrev_b32 v105, 17, v65
    v_and_b32 v89, 0x3fff0, v65
    v_and_or_b32 v97, v65, v43, v144
    v_lshrrev_b32 v106, 17, v66
    v_and_b32 v90, 0x3fff0, v66
    s_waitcnt lgkmcnt(0)
    s_barrier
    ds_read2_b32 v[48:49], v44 offset0:0 offset1:2
    ds_read2_b32 v[50:51], v44 offset0:4 offset1:6
    ds_read_b32 v34, v47

    s_mov_b32 s29, 12288
    buffer_load_dwordx4 v[228:231], v165, s[48:51], s29 offen
    v_min_u32 v35, 4, v72
    v_add_u32 v80, v80, v35
    v_min_u32 v35, 4, v73
    v_add_u32 v81, v81, v35
    v_min_u32 v35, 4, v74
    v_add_u32 v82, v82, v35
    v_min_u32 v35, 4, v75
    v_add_u32 v83, v83, v35
    s_cmp_eq_u32 s28, 0
    s_cbranch_scc1 E_sk2
    v_min_u32 v35, 4, v76
    v_add_u32 v84, v84, v35
    v_min_u32 v35, 4, v77
    v_add_u32 v85, v85, v35
    v_min_u32 v35, 4, v78
    v_add_u32 v86, v86, v35
    v_min_u32 v35, 4, v79
    v_add_u32 v87, v87, v35
E_sk2:
    s_waitcnt lgkmcnt(0)
    v_add_u32 v52, v48, v49
    v_add_u32 v56, 16, v48
    v_add_u32 v53, v52, v50
    v_add_u32 v57, 16, v52
    v_add_u32 v54, v53, v51
    v_add_u32 v58, 16, v53
    v_add_u32 v59, 16, v54
    v_lshrrev_b32 v56, 5, v56
    v_lshrrev_b32 v57, 5, v57
    v_lshrrev_b32 v58, 5, v58
    v_lshrrev_b32 v59, 5, v59
    v_lshl_or_b32 v60, v57, 16, v56
    v_lshl_or_b32 v61, v59, 16, v58
    v_mov_b32 v62, v60
    v_mov_b32 v63, v61
    v_and_or_b32 v98, v66, v43, v144
    v_add_u32_dpp v62, v62, v62 row_shr:1 row_mask:0xf bank_mask:0xf
    v_add_u32_dpp v63, v63, v63 row_shr:1 row_mask:0xf bank_mask:0xf
    v_lshrrev_b32 v107, 17, v67
    v_add_u32_dpp v62, v62, v62 row_shr:2 row_mask:0xf bank_mask:0xf
    v_add_u32_dpp v63, v63, v63 row_shr:2 row_mask:0xf bank_mask:0xf
    v_and_b32 v91, 0x3fff0, v67
    v_add_u32_dpp v62, v62, v62 row_shr:4 row_mask:0xf bank_mask:0xf
    v_add_u32_dpp v63, v63, v63 row_shr:4 row_mask:0xf bank_mask:0xf
    v_and_or_b32 v99, v67, v43, v144
    v_add_u32_dpp v62, v62, v62 row_shr:8 row_mask:0xf bank_mask:0xf
    v_add_u32_dpp v63, v63, v63 row_shr:8 row_mask:0xf bank_mask:0xf
    v_sub_u32 v60, v62, v60
    v_sub_u32 v61, v63, v61
    v_mov_b32_dpp v55, v62 row_newbcast:15 row_mask:0xf bank_mask:0xf
    v_mov_b32_dpp v54, v63 row_newbcast:15 row_mask:0xf bank_mask:0xf
    v_sub_u32 v55, v55, v62
    v_sub_u32 v54, v54, v63
    v_alignbit_b32 v56, v61, v60, 16
    v_lshrrev_b32 v57, 16, v61
    v_add_u32 v55, v55, v56
    v_add_u32 v54, v54, v57
    v_and_b32 v60, 0xffff, v60
    v_and_b32 v56, 0xffff, v55
    v_lshrrev_b32 v57, 16, v55
    v_and_b32 v58, 0xffff, v54
    v_add_u32 v59, v48, v45
    v_add_u32 v61, v52, v45
    v_add_u32 v62, v53, v45
    v_lshl_add_u32 v169, v60, 5, v45
    v_lshl_add_u32 v171, v56, 5, v59
    v_lshl_add_u32 v173, v57, 5, v61
    v_lshl_add_u32 v175, v58, 5, v62
    v_cmp_eq_u32 s[32:33], 0, v49
    v_cmp_eq_u32 s[34:35], 0, v50
    v_add_u32 v56, v169, v48
    v_add_u32 v57, v171, v49
    v_add_u32 v58, v173, v50
    v_and_b32 v59, 16, v48
    v_and_b32 v60, 16, v52
    v_and_b32 v61, 16, v53
    v_cndmask_b32 v57, v57, v56, s[32:33]
    v_cmp_ne_u32 vcc, 0, v59
    v_cmp_ne_u32 s[32:33], 0, v60
    v_cndmask_b32 v58, v58, v57, s[34:35]
    v_cmp_ne_u32 s[34:35], 0, v61
    v_mov_b32 v168, v169
    v_cndmask_b32 v170, v171, v56, vcc
    v_cndmask_b32 v172, v173, v57, s[32:33]
    v_cndmask_b32 v174, v175, v58, s[34:35]
    ds_write_b128 v44, v[168:171] offset:3072
    ds_write_b128 v44, v[172:175] offset:3088

    ds_read_b32 v80, v80 offset:3072
    ds_read_b32 v81, v81 offset:3072
    ds_read_b32 v82, v82 offset:3072
    ds_read_b32 v83, v83 offset:3072
    s_cmp_eq_u32 s28, 0
    s_cbranch_scc1 E_sk3
    ds_read_b32 v84, v84 offset:3072
    ds_read_b32 v85, v85 offset:3072
    ds_read_b32 v86, v86 offset:3072
    ds_read_b32 v87, v87 offset:3072
    v_lshrrev_b32 v108, 17, v68
    v_and_b32 v92, 0x3fff0, v68
    v_and_or_b32 v100, v68, v43, v145
    v_lshrrev_b32 v109, 17, v69
    v_and_b32 v93, 0x3fff0, v69
    v_and_or_b32 v101, v69, v43, v145
    v_lshrrev_b32 v110, 17, v70
    v_and_b32 v94, 0x3fff0, v70
    v_and_or_b32 v102, v70, v43, v145
    v_lshrrev_b32 v111, 17, v71
    v_and_b32 v95, 0x3fff0, v71
    v_and_or_b32 v103, v71, v43, v145
E_sk3:
    s_mov_b32 s29, 16384
    buffer_load_dwordx4 v[232:235], v165, s[48:51], s29 offen
    s_lshl_b32 s96, s4, 4
    v_readlane_b32 s32, v63, 15
    s_add_u32 s96, s96, 15
    v_readlane_b32 s33, v63, 31
    v_readlane_b32 s34, v63, 47
    v_readlane_b32 s35, v63, 63
    v_readlane_b32 s96, v63, s96
    v_readfirstlane_b32 s98, v34
    s_max_u32 s32, s32, s33
    s_max_u32 s34, s34, s35
    s_max_u32 s32, s32, s34
    s_lshr_b32 s32, s32, 16
    s_lshr_b32 s96, s96, 16
    s_cmp_eq_u32 s6, 0
    s_cselect_b32 s99, s98, s99
    s_mov_b32 s98, 0
    s_waitcnt lgkmcnt(0)

    s_cmp_gt_u32 s32, 288
    s_cbranch_scc0 E_nopend
    s_mov_b32 s98, 1
    s_min_u32 s96, s96, 288
    s_add_u32 s12, s30, 0xe01000
    s_addc_u32 s13, s31, 0
    s_mov_b32 s14, 0x811000
    s_mov_b32 s15, 0x20000
    v_bfe_u32 v48, v64, 22, 2
    v_add_u32 v49, v72, v80
    v_add_u32 v48, 1, v48
    v_mul_u32_u24 v48, 9216, v48
    v_cmp_lt_u32 vcc, v49, v48
    s_and_b64 s[64:65], s[64:65], vcc
    s_nop 1
    v_cndmask_b32 v64, v64, 0, s[64:65]
    v_bfe_u32 v48, v65, 22, 2
    v_add_u32 v49, v73, v81
    v_add_u32 v48, 1, v48
    v_mul_u32_u24 v48, 9216, v48
    v_cmp_lt_u32 vcc, v49, v48
    s_and_b64 s[66:67], s[66:67], vcc
    s_nop 1
    v_cndmask_b32 v65, v65, 0, s[66:67]
    v_bfe_u32 v48, v66, 22, 2
    v_add_u32 v49, v74, v82
    v_add_u32 v48, 1, v48
    v_mul_u32_u24 v48, 9216, v48
    v_cmp_lt_u32 vcc, v49, v48
    s_and_b64 s[68:69], s[68:69], vcc
    s_nop 1
    v_cndmask_b32 v66, v66, 0, s[68:69]
    v_bfe_u32 v48, v67, 22, 2
    v_add_u32 v49, v75, v83
    v_add_u32 v48, 1, v48
    v_mul_u32_u24 v48, 9216, v48
    v_cmp_lt_u32 vcc, v49, v48
    s_and_b64 s[70:71], s[70:71], vcc
    s_nop 1
    v_cndmask_b32 v67, v67, 0, s[70:71]
    s_cmp_eq_u32 s28, 0
    s_cbranch_scc1 E_sk4
    v_bfe_u32 v48, v68, 22, 2
    v_add_u32 v49, v76, v84
    v_add_u32 v48, 1, v48
    v_mul_u32_u24 v48, 9216, v48
    v_cmp_lt_u32 vcc, v49, v48
    s_and_b64 s[72:73], s[72:73], vcc
    s_nop 1
    v_cndmask_b32 v68, v68, 0, s[72:73]
    v_bfe_u32 v48, v69, 22, 2
    v_add_u32 v49, v77, v85
    v_add_u32 v48, 1, v48
    v_mul_u32_u24 v48, 9216, v48
    v_cmp_lt_u32 vcc, v49, v48
    s_and_b64 s[74:75], s[74:75], vcc
    s_nop 1
    v_cndmask_b32 v69, v69, 0, s[74:75]
    v_bfe_u32 v48, v70, 22, 2
    v_add_u32 v49, v78, v86
    v_add_u32 v48, 1, v48
    v_mul_u32_u24 v48, 9216, v48
    v_cmp_lt_u32 vcc, v49, v48
    s_and_b64 s[76:77], s[76:77], vcc
    s_nop 1
    v_cndmask_b32 v70, v70, 0, s[76:77]
    v_bfe_u32 v48, v71, 22, 2
    v_add_u32 v49, v79, v87
    v_add_u32 v48, 1, v48
    v_mul_u32_u24 v48, 9216, v48
    v_cmp_lt_u32 vcc, v49, v48
    s_and_b64 s[78:79], s[78:79], vcc
    s_nop 1
    v_cndmask_b32 v71, v71, 0, s[78:79]
E_sk4:
    s_lshl_b32 s33, s2, 14
    s_add_u32 s33, s33, 0x411000
    v_lshlrev_b32 v48, 5, v209
    v_add_u32 v48, s33, v48

    buffer_store_dwordx4 v[64:67], v48, s[12:15], 0 offen offset:0
    buffer_store_dwordx4 v[68:71], v48, s[12:15], 0 offen offset:16
    s_waitcnt vmcnt(0)
E_nopend:
    v_add_u32 v72, v72, v80
    v_add_u32 v73, v73, v81
    v_add_u32 v74, v74, v82
    v_add_u32 v75, v75, v83
    v_bfi_b32 v104, 30, v104, v72
    v_lshrrev_b32 v72, 2, v72
    v_bfi_b32 v105, 30, v105, v73
    v_lshrrev_b32 v73, 2, v73
    v_bfi_b32 v106, 30, v106, v74
    v_lshrrev_b32 v74, 2, v74
    v_bfi_b32 v107, 30, v107, v75
    v_lshrrev_b32 v75, 2, v75
    s_mov_b64 exec, s[64:65]
    ds_write2st64_b32 v72, v88, v96 offset0:20 offset1:57
    ds_write_b16 v104, v41 offset:23808
    s_mov_b64 exec, s[66:67]
    ds_write2st64_b32 v73, v89, v97 offset0:20 offset1:57
    ds_write_b16 v105, v41 offset:23808
    s_mov_b64 exec, s[68:69]
    ds_write2st64_b32 v74, v90, v98 offset0:20 offset1:57
    ds_write_b16 v106, v41 offset:23808
    s_mov_b64 exec, s[70:71]
    ds_write2st64_b32 v75, v91, v99 offset0:20 offset1:57
    ds_write_b16 v107, v41 offset:23808
    s_mov_b64 exec, -1
    s_cmp_eq_u32 s28, 0
    s_cbranch_scc1 E_sk5
    v_add_u32 v76, v76, v84
    v_add_u32 v77, v77, v85
    v_add_u32 v78, v78, v86
    v_add_u32 v79, v79, v87
    v_bfi_b32 v108, 30, v108, v76
    v_lshrrev_b32 v76, 2, v76
    v_bfi_b32 v109, 30, v109, v77
    v_lshrrev_b32 v77, 2, v77
    v_bfi_b32 v110, 30, v110, v78
    v_lshrrev_b32 v78, 2, v78
    v_bfi_b32 v111, 30, v111, v79
    v_lshrrev_b32 v79, 2, v79
    s_mov_b64 exec, s[72:73]
    ds_write2st64_b32 v76, v92, v100 offset0:20 offset1:57
    ds_write_b16 v108, v41 offset:23808
    s_mov_b64 exec, s[74:75]
    ds_write2st64_b32 v77, v93, v101 offset0:20 offset1:57
    ds_write_b16 v109, v41 offset:23808
    s_mov_b64 exec, s[76:77]
    ds_write2st64_b32 v78, v94, v102 offset0:20 offset1:57
    ds_write_b16 v110, v41 offset:23808
    s_mov_b64 exec, s[78:79]
    ds_write2st64_b32 v79, v95, v103 offset0:20 offset1:57
    ds_write_b16 v111, v41 offset:23808
    s_mov_b64 exec, -1
E_sk5:
    s_mov_b32 s29, 20480
    buffer_load_dwordx4 v[236:239], v165, s[48:51], s29 offen
    s_add_u32 s96, s96, 15
    s_lshr_b32 s96, s96, 4
    s_mov_b32 s23, 0

    v_mov_b32 v139, v165
    s_waitcnt vmcnt(6) lgkmcnt(0)
    s_barrier
    ds_read_b32 v207, v205
    ds_read_b128 v[112:115], v204 offset:0
    ds_read_b128 v[116:119], v204 offset:32
    ds_read_b128 v[120:123], v204 offset:64
    ds_read_b128 v[124:127], v204 offset:96
    ds_read_b32 v253, v205 offset:256
    ds_read_b128 v[160:163], v204 offset:128
    ds_read_b128 v[164:167], v204 offset:160
    ds_read_b128 v[168:171], v204 offset:192
    ds_read_b128 v[172:175], v204 offset:224
    ds_read_b128 v[196:199], v201
    s_mov_b32 s29, 24576
    buffer_load_dwordx4 v[240:243], v139, s[48:51], s29 offen
    s_mov_b32 s29, 28672
    buffer_load_dwordx4 v[244:247], v139, s[48:51], s29 offen
    s_waitcnt lgkmcnt(10)
    v_and_b32 v208, 15, v207
    v_and_b32 v210, 0x3ff0, v207
    v_lshrrev_b32 v207, 15, v207
    v_add_u32 v207, v207, v206
    v_lshl_add_u32 v207, v208, 5, v207
    v_mad_u32_u24 v207, v210, s22, v207
    s_cmp_lg_u32 s5, 0
    s_cbranch_scc1 E_d0
    buffer_load_dwordx4 v207, s[56:59], 0 offen lds
    s_branch E_d00
E_d0:
    s_lshl_b32 s33, s4, 10
    s_add_u32 s33, s33, 61440
    s_mov_b32 m0, s33
    s_add_u32 s33, s20, s21
    buffer_load_dwordx4 v139, s[40:43], 0 offen lds
    s_mov_b32 m0, s33

E_d00:
    s_waitcnt lgkmcnt(5)
    v_and_b32 v208, 15, v253
    v_and_b32 v210, 0x3ff0, v253
    v_lshrrev_b32 v253, 15, v253
    v_add_u32 v253, v253, v206
    v_lshl_add_u32 v253, v208, 5, v253
    v_mad_u32_u24 v253, v210, s22, v253
    s_cmp_eq_u32 s6, 0
    s_cbranch_scc1 E_gemm
    buffer_load_dword v64, v112, s[52:55], 0 offen
    buffer_load_dword v65, v113, s[52:55], 0 offen
    buffer_load_dword v66, v114, s[52:55], 0 offen
    buffer_load_dword v67, v115, s[52:55], 0 offen
    buffer_load_dword v68, v116, s[52:55], 0 offen
    buffer_load_dword v69, v117, s[52:55], 0 offen
    buffer_load_dword v70, v118, s[52:55], 0 offen
    buffer_load_dword v71, v119, s[52:55], 0 offen
    buffer_load_dword v72, v120, s[52:55], 0 offen
    buffer_load_dword v73, v121, s[52:55], 0 offen
    buffer_load_dword v74, v122, s[52:55], 0 offen
    buffer_load_dword v75, v123, s[52:55], 0 offen
    buffer_load_dword v76, v124, s[52:55], 0 offen
    buffer_load_dword v77, v125, s[52:55], 0 offen
    buffer_load_dword v78, v126, s[52:55], 0 offen
    buffer_load_dword v79, v127, s[52:55], 0 offen
    s_branch E_nogemm
E_gemm:
    v_xor_b32 v251, 0, v136
    ds_read_b128 v[32:35], v251
    ds_read_b128 v[36:39], v251 offset:512
    v_xor_b32 v251, 32, v136
    ds_read_b128 v[40:43], v251
    ds_read_b128 v[44:47], v251 offset:512
    v_xor_b32 v251, 64, v136
    ds_read_b128 v[48:51], v251
    ds_read_b128 v[52:55], v251 offset:512
    v_xor_b32 v251, 96, v136
    ds_read_b128 v[56:59], v251
    ds_read_b128 v[60:63], v251 offset:512
    s_waitcnt vmcnt(8) lgkmcnt(6)
    v_mfma_f32_32x32x16_bf16 v[0:15], v[32:35], v[216:219], 0
    v_mfma_f32_32x32x16_bf16 v[16:31], v[36:39], v[216:219], 0
    v_xor_b32 v251, 128, v136
    ds_read_b128 v[32:35], v251
    ds_read_b128 v[36:39], v251 offset:512
    buffer_load_dword v64, v112, s[52:55], 0 offen
    buffer_load_dword v65, v113, s[52:55], 0 offen
    s_waitcnt vmcnt(9) lgkmcnt(6)
    v_mfma_f32_32x32x16_bf16 v[0:15], v[40:43], v[220:223], v[0:15]
    v_mfma_f32_32x32x16_bf16 v[16:31], v[44:47], v[220:223], v[16:31]
    v_xor_b32 v251, 160, v136
    ds_read_b128 v[40:43], v251
    ds_read_b128 v[44:47], v251 offset:512
    buffer_load_dword v66, v114, s[52:55], 0 offen
    buffer_load_dword v67, v115, s[52:55], 0 offen
    s_waitcnt vmcnt(10) lgkmcnt(6)
    v_mfma_f32_32x32x16_bf16 v[0:15], v[48:51], v[224:227], v[0:15]
    v_mfma_f32_32x32x16_bf16 v[16:31], v[52:55], v[224:227], v[16:31]
    v_xor_b32 v251, 192, v136
    ds_read_b128 v[48:51], v251
    ds_read_b128 v[52:55], v251 offset:512
    buffer_load_dword v68, v116, s[52:55], 0 offen
    buffer_load_dword v69, v117, s[52:55], 0 offen
    s_waitcnt vmcnt(11) lgkmcnt(6)
    v_mfma_f32_32x32x16_bf16 v[0:15], v[56:59], v[228:231], v[0:15]
    v_mfma_f32_32x32x16_bf16 v[16:31], v[60:63], v[228:231], v[16:31]
    v_xor_b32 v251, 224, v136
    ds_read_b128 v[56:59], v251
    ds_read_b128 v[60:63], v251 offset:512
    buffer_load_dword v70, v118, s[52:55], 0 offen
    buffer_load_dword v71, v119, s[52:55], 0 offen
    s_waitcnt vmcnt(12) lgkmcnt(6)
    v_mfma_f32_32x32x16_bf16 v[0:15], v[32:35], v[232:235], v[0:15]
    v_mfma_f32_32x32x16_bf16 v[16:31], v[36:39], v[232:235], v[16:31]
    buffer_load_dword v72, v120, s[52:55], 0 offen
    buffer_load_dword v73, v121, s[52:55], 0 offen
    s_waitcnt vmcnt(13) lgkmcnt(4)
    v_mfma_f32_32x32x16_bf16 v[0:15], v[40:43], v[236:239], v[0:15]
    v_mfma_f32_32x32x16_bf16 v[16:31], v[44:47], v[236:239], v[16:31]
    buffer_load_dword v74, v122, s[52:55], 0 offen
    buffer_load_dword v75, v123, s[52:55], 0 offen
    s_waitcnt vmcnt(14) lgkmcnt(2)
    v_mfma_f32_32x32x16_bf16 v[0:15], v[48:51], v[240:243], v[0:15]
    v_mfma_f32_32x32x16_bf16 v[16:31], v[52:55], v[240:243], v[16:31]
    buffer_load_dword v76, v124, s[52:55], 0 offen
    buffer_load_dword v77, v125, s[52:55], 0 offen
    s_waitcnt vmcnt(15) lgkmcnt(0)
    v_mfma_f32_32x32x16_bf16 v[0:15], v[56:59], v[244:247], v[0:15]
    v_mfma_f32_32x32x16_bf16 v[16:31], v[60:63], v[244:247], v[16:31]
    buffer_load_dword v78, v126, s[52:55], 0 offen
    buffer_load_dword v79, v127, s[52:55], 0 offen
    v_mov_b32 v251, 0xbfb8aa3b
    s_nop 6
    s_cmp_ge_u32 s3, 4
    s_cbranch_scc1 E_nosc
    v_mul_f32 v0, v251, v0
    v_mul_f32 v1, v251, v1
    v_mul_f32 v2, v251, v2
    v_mul_f32 v3, v251, v3
    v_mul_f32 v4, v251, v4
    v_mul_f32 v5, v251, v5
    v_mul_f32 v6, v251, v6
    v_mul_f32 v7, v251, v7
    v_mul_f32 v8, v251, v8
    v_mul_f32 v9, v251, v9
    v_mul_f32 v10, v251, v10
    v_mul_f32 v11, v251, v11
    v_mul_f32 v12, v251, v12
    v_mul_f32 v13, v251, v13
    v_mul_f32 v14, v251, v14
    v_mul_f32 v15, v251, v15
    v_mul_f32 v16, v251, v16
    v_mul_f32 v17, v251, v17
    v_mul_f32 v18, v251, v18
    v_mul_f32 v19, v251, v19
    v_mul_f32 v20, v251, v20
    v_mul_f32 v21, v251, v21
    v_mul_f32 v22, v251, v22
    v_mul_f32 v23, v251, v23
    v_mul_f32 v24, v251, v24
    v_mul_f32 v25, v251, v25
    v_mul_f32 v26, v251, v26
    v_mul_f32 v27, v251, v27
    v_mul_f32 v28, v251, v28
    v_mul_f32 v29, v251, v29
    v_mul_f32 v30, v251, v30
    v_mul_f32 v31, v251, v31
    v_cvt_pk_bf16_f32 v32, v0, v1
    v_cvt_pk_bf16_f32 v33, v2, v3
    v_cvt_pk_bf16_f32 v34, v4, v5
    v_cvt_pk_bf16_f32 v35, v6, v7
    v_cvt_pk_bf16_f32 v36, v8, v9
    v_cvt_pk_bf16_f32 v37, v10, v11
    v_cvt_pk_bf16_f32 v38, v12, v13
    v_cvt_pk_bf16_f32 v39, v14, v15
    v_cvt_pk_bf16_f32 v40, v16, v17
    v_cvt_pk_bf16_f32 v41, v18, v19
    v_cvt_pk_bf16_f32 v42, v20, v21
    v_cvt_pk_bf16_f32 v43, v22, v23
    v_cvt_pk_bf16_f32 v44, v24, v25
    v_cvt_pk_bf16_f32 v45, v26, v27
    v_cvt_pk_bf16_f32 v46, v28, v29
    v_cvt_pk_bf16_f32 v47, v30, v31
    ds_write_b128 v137, v[32:35] offset:0
    ds_write_b128 v137, v[36:39] offset:4096
    ds_write_b128 v137, v[40:43] offset:8192
    ds_write_b128 v137, v[44:47] offset:12288
    s_branch E_sc
E_nosc:
    ds_write_b128 v137, v[0:3] offset:0
    ds_write_b128 v137, v[4:7] offset:1024
    ds_write_b128 v137, v[8:11] offset:8192
    ds_write_b128 v137, v[12:15] offset:9216
    ds_write_b128 v137, v[16:19] offset:16384
    ds_write_b128 v137, v[20:23] offset:17408
    ds_write_b128 v137, v[24:27] offset:24576
    ds_write_b128 v137, v[28:31] offset:25600
E_sc:
    v_mov_b32 v8, 0x358637bd
    v_mov_b32 v9, 0x358637bd
    v_mov_b64 v[0:1], 0
    v_mov_b64 v[2:3], 0
    v_mov_b64 v[4:5], 0
    v_mov_b64 v[6:7], 0
    v_mov_b64 v[10:11], v[8:9]
    v_mov_b64 v[12:13], v[8:9]
    v_mov_b64 v[14:15], v[8:9]
    v_mov_b64 v[16:17], 0
    v_mov_b64 v[18:19], 0
    v_mov_b64 v[20:21], 0
    v_mov_b64 v[22:23], 0
    v_mov_b64 v[24:25], v[8:9]
    v_mov_b64 v[26:27], v[8:9]
    v_mov_b64 v[28:29], v[8:9]
    v_mov_b64 v[30:31], v[8:9]
E_nogemm:
    s_waitcnt vmcnt(16) lgkmcnt(0)
    s_barrier
    s_lshl_b32 s33, s5, 11
    v_add_u32 v251, s33, v139
    ds_read_b128 v[192:195], v200
    ds_read_b128 v[176:179], v251 offset:61440
    ds_read_b128 v[180:183], v251 offset:62464
    ds_read_b128 v[184:187], v138
    ds_read_b128 v[188:191], v138 offset:1024
    v_add_u32 v200, 1024, v200
    v_add_u32 v212, 1, v212
    s_cmp_lg_u32 s96, 0
    s_cbranch_scc1 E_go

    v_lshrrev_b32 v224, 9, v139
    v_lshrrev_b32 v225, 6, v139
    v_lshrrev_b32 v226, 2, v139
    s_lshl_b32 s33, s5, 3
    v_xor_b32 v225, s33, v225
    v_and_b32 v226, 12, v226
    s_lshl_b32 s33, s4, 8
    s_add_u32 s33, s33, 98304
    v_lshl_add_u32 v226, v225, 4, v226
    v_lshl_add_u32 v226, v224, 13, v226
    v_add_u32 v226, s33, v226
    v_xor_b32 v232, 0, v226
    v_xor_b32 v233, 16, v226
    v_xor_b32 v234, 32, v226
    v_xor_b32 v235, 48, v226
    v_xor_b32 v236, 64, v226
    v_xor_b32 v237, 80, v226
    v_xor_b32 v238, 96, v226
    v_xor_b32 v239, 112, v226
    ds_read_b32 v216, v232 offset:0
    ds_read_b32 v217, v233 offset:1024
    ds_read_b32 v218, v234 offset:2048
    ds_read_b32 v219, v235 offset:3072
    ds_read_b32 v220, v236 offset:4096
    ds_read_b32 v221, v237 offset:5120
    ds_read_b32 v222, v238 offset:6144
    ds_read_b32 v223, v239 offset:7168
    s_waitcnt lgkmcnt(0)
    s_lshl_b32 s33, s3, 12
    s_add_u32 s33, s33, 131072
    v_add_u32 v139, s33, v139
    ds_read_b128 v[232:235], v139 offset:0
    ds_read_b128 v[236:239], v139 offset:1024
    ds_read_b128 v[240:243], v139 offset:2048
    ds_read_b128 v[244:247], v139 offset:3072
    v_and_b32 v224, 0xffff0000, v216
    v_lshlrev_b32 v216, 16, v216
    v_and_b32 v225, 0xffff0000, v217
    v_lshlrev_b32 v217, 16, v217
    v_and_b32 v226, 0xffff0000, v218
    v_lshlrev_b32 v218, 16, v218
    v_and_b32 v227, 0xffff0000, v219
    v_lshlrev_b32 v219, 16, v219
    v_and_b32 v228, 0xffff0000, v220
    v_lshlrev_b32 v220, 16, v220
    v_and_b32 v229, 0xffff0000, v221
    v_lshlrev_b32 v221, 16, v221
    v_and_b32 v230, 0xffff0000, v222
    v_lshlrev_b32 v222, 16, v222
    v_and_b32 v231, 0xffff0000, v223
    v_lshlrev_b32 v223, 16, v223
    s_waitcnt lgkmcnt(0)
    s_branch E_done
E_go:
    buffer_load_dword v80, v112, s[52:55], 0 offen offset:4
    buffer_load_dword v81, v113, s[52:55], 0 offen offset:4
    buffer_load_dword v82, v114, s[52:55], 0 offen offset:4
    buffer_load_dword v83, v115, s[52:55], 0 offen offset:4
    buffer_load_dword v84, v116, s[52:55], 0 offen offset:4
    buffer_load_dword v85, v117, s[52:55], 0 offen offset:4
    buffer_load_dword v86, v118, s[52:55], 0 offen offset:4
    buffer_load_dword v87, v119, s[52:55], 0 offen offset:4
    buffer_load_dword v88, v120, s[52:55], 0 offen offset:4
    buffer_load_dword v89, v121, s[52:55], 0 offen offset:4
    buffer_load_dword v90, v122, s[52:55], 0 offen offset:4
    buffer_load_dword v91, v123, s[52:55], 0 offen offset:4
    buffer_load_dword v92, v124, s[52:55], 0 offen offset:4
    buffer_load_dword v93, v125, s[52:55], 0 offen offset:4
    buffer_load_dword v94, v126, s[52:55], 0 offen offset:4
    buffer_load_dword v95, v127, s[52:55], 0 offen offset:4
    v_lshrrev_b32 v224, 9, v139
    v_lshrrev_b32 v225, 6, v139
    v_lshrrev_b32 v226, 2, v139
    s_lshl_b32 s33, s5, 3
    v_xor_b32 v225, s33, v225
    v_and_b32 v226, 12, v226
    s_lshl_b32 s33, s4, 8
    s_add_u32 s33, s33, 98304
    v_lshl_add_u32 v226, v225, 4, v226
    v_lshl_add_u32 v226, v224, 13, v226
    v_add_u32 v226, s33, v226
    v_xor_b32 v232, 0, v226
    v_xor_b32 v233, 16, v226
    v_xor_b32 v234, 32, v226
    v_xor_b32 v235, 48, v226
    v_xor_b32 v236, 64, v226
    v_xor_b32 v237, 80, v226
    v_xor_b32 v238, 96, v226
    v_xor_b32 v239, 112, v226
    ds_read_b32 v216, v232 offset:0
    ds_read_b32 v217, v233 offset:1024
    ds_read_b32 v218, v234 offset:2048
    ds_read_b32 v219, v235 offset:3072
    ds_read_b32 v220, v236 offset:4096
    ds_read_b32 v221, v237 offset:5120
    ds_read_b32 v222, v238 offset:6144
    ds_read_b32 v223, v239 offset:7168
    s_waitcnt lgkmcnt(8)
    v_mfma_f32_32x32x16_bf16 v[32:47], v[192:195], v[176:179], 0
    v_mfma_f32_32x32x16_bf16 v[32:47], v[196:199], v[184:187], v[32:47]
    s_waitcnt vmcnt(16) lgkmcnt(0)
    v_smfmac_f32_32x32x32_bf16 v[32:47], v[128:131], v[64:71], v203 abid:1
    v_smfmac_f32_32x32x32_bf16 v[32:47], v[132:135], v[72:79], v203 abid:1
    s_cmp_ge_u32 s3, 4
    s_cbranch_scc1 E_entB
    s_setprio 2
    s_nop 8
    v_exp_f32 v32, v32
    v_exp_f32 v33, v33
    v_exp_f32 v34, v34
    v_exp_f32 v35, v35
    v_exp_f32 v36, v36
    v_exp_f32 v37, v37
    v_exp_f32 v38, v38
    v_mfma_f32_32x32x16_bf16 v[48:63], v[192:195], v[180:183], 0
    v_exp_f32 v39, v39
    v_exp_f32 v40, v40
    v_exp_f32 v41, v41
    v_exp_f32 v42, v42
    v_exp_f32 v43, v43
    v_mfma_f32_32x32x16_bf16 v[48:63], v[196:199], v[188:191], v[48:63]
    v_exp_f32 v44, v44
    v_exp_f32 v45, v45
    v_exp_f32 v46, v46
    v_exp_f32 v47, v47
    v_add_f32 v32, 1.0, v32
    v_add_f32 v33, 1.0, v33
    v_add_f32 v34, 1.0, v34
    v_add_f32 v35, 1.0, v35
    v_add_f32 v36, 1.0, v36
    v_add_f32 v37, 1.0, v37
    v_add_f32 v38, 1.0, v38
    v_add_f32 v39, 1.0, v39
    v_add_f32 v40, 1.0, v40
    v_add_f32 v41, 1.0, v41
    v_add_f32 v42, 1.0, v42
    v_add_f32 v43, 1.0, v43
    v_add_f32 v44, 1.0, v44
    v_add_f32 v45, 1.0, v45
    v_add_f32 v46, 1.0, v46
    v_add_f32 v47, 1.0, v47
    s_cmp_eq_u32 s5, 0
    s_cbranch_scc1 E_d1A
    buffer_load_dwordx4 v207, s[56:59], 0 offen lds
    buffer_load_dword v96, v160, s[52:55], 0 offen
    buffer_load_dword v97, v161, s[52:55], 0 offen
    buffer_load_dword v98, v162, s[52:55], 0 offen
    buffer_load_dword v99, v163, s[52:55], 0 offen
    buffer_load_dword v100, v164, s[52:55], 0 offen
    buffer_load_dword v101, v165, s[52:55], 0 offen
    buffer_load_dword v102, v166, s[52:55], 0 offen
    buffer_load_dword v103, v167, s[52:55], 0 offen
    buffer_load_dword v104, v168, s[52:55], 0 offen
    buffer_load_dword v105, v169, s[52:55], 0 offen
    buffer_load_dword v106, v170, s[52:55], 0 offen
    buffer_load_dword v107, v171, s[52:55], 0 offen
    buffer_load_dword v108, v172, s[52:55], 0 offen
    buffer_load_dword v109, v173, s[52:55], 0 offen
    buffer_load_dword v110, v174, s[52:55], 0 offen
    buffer_load_dword v111, v175, s[52:55], 0 offen
    s_branch E_d2A
E_d1A:
    s_add_u32 s21, s21, 2048
    s_add_u32 s33, s20, s21
    s_mov_b32 m0, s33
    buffer_load_dword v96, v160, s[52:55], 0 offen
    buffer_load_dword v97, v161, s[52:55], 0 offen
    buffer_load_dword v98, v162, s[52:55], 0 offen
    buffer_load_dword v99, v163, s[52:55], 0 offen
    buffer_load_dword v100, v164, s[52:55], 0 offen
    buffer_load_dword v101, v165, s[52:55], 0 offen
    buffer_load_dword v102, v166, s[52:55], 0 offen
    buffer_load_dword v103, v167, s[52:55], 0 offen
    buffer_load_dwordx4 v253, s[56:59], 0 offen lds
    buffer_load_dword v104, v168, s[52:55], 0 offen
    buffer_load_dword v105, v169, s[52:55], 0 offen
    buffer_load_dword v106, v170, s[52:55], 0 offen
    buffer_load_dword v107, v171, s[52:55], 0 offen
    buffer_load_dword v108, v172, s[52:55], 0 offen
    buffer_load_dword v109, v173, s[52:55], 0 offen
    buffer_load_dword v110, v174, s[52:55], 0 offen
    buffer_load_dword v111, v175, s[52:55], 0 offen
E_d2A:
    v_mov_b32 v207, v253
    s_waitcnt vmcnt(17)
    v_rcp_f32 v32, v32
    v_rcp_f32 v33, v33
    v_smfmac_f32_32x32x32_bf16 v[48:63], v[128:131], v[80:87], v203 abid:1
    v_rcp_f32 v34, v34
    v_rcp_f32 v35, v35
    v_rcp_f32 v36, v36
    v_rcp_f32 v37, v37
    v_rcp_f32 v38, v38
    v_rcp_f32 v39, v39
    v_rcp_f32 v40, v40
    v_smfmac_f32_32x32x32_bf16 v[48:63], v[132:135], v[88:95], v203 abid:1
    v_rcp_f32 v41, v41
    v_rcp_f32 v42, v42
    v_rcp_f32 v43, v43
    v_rcp_f32 v44, v44
    v_rcp_f32 v45, v45
    v_rcp_f32 v46, v46
    v_rcp_f32 v47, v47
    v_add_f32 v152, v32, v33
    v_add_f32 v153, v34, v35
    v_add_f32 v154, v36, v37
    v_add_f32 v155, v38, v39
    v_add_f32 v156, v40, v41
    v_add_f32 v157, v42, v43
    v_add_f32 v158, v44, v45
    v_add_f32 v159, v46, v47
    v_mul_f32 v32, v32, v64
    v_mul_f32 v34, v34, v66
    v_mul_f32 v36, v36, v68
    v_mul_f32 v38, v38, v70
    v_mul_f32 v40, v40, v72
    v_mul_f32 v42, v42, v74
    v_mul_f32 v44, v44, v76
    v_mul_f32 v46, v46, v78
    v_fmac_f32 v32, v33, v65
    v_fmac_f32 v34, v35, v67
    v_fmac_f32 v36, v37, v69
    v_fmac_f32 v38, v39, v71
    v_fmac_f32 v40, v41, v73
    v_fmac_f32 v42, v43, v75
    v_fmac_f32 v44, v45, v77
    v_fmac_f32 v46, v47, v79
    buffer_load_dword v112, v160, s[52:55], 0 offen offset:4
    buffer_load_dword v113, v161, s[52:55], 0 offen offset:4
    buffer_load_dword v114, v162, s[52:55], 0 offen offset:4
    buffer_load_dword v115, v163, s[52:55], 0 offen offset:4
    buffer_load_dword v116, v164, s[52:55], 0 offen offset:4
    buffer_load_dword v117, v165, s[52:55], 0 offen offset:4
    buffer_load_dword v118, v166, s[52:55], 0 offen offset:4
    buffer_load_dword v119, v167, s[52:55], 0 offen offset:4
    buffer_load_dword v120, v168, s[52:55], 0 offen offset:4
    buffer_load_dword v121, v169, s[52:55], 0 offen offset:4
    buffer_load_dword v122, v170, s[52:55], 0 offen offset:4
    buffer_load_dword v123, v171, s[52:55], 0 offen offset:4
    buffer_load_dword v124, v172, s[52:55], 0 offen offset:4
    buffer_load_dword v125, v173, s[52:55], 0 offen offset:4
    buffer_load_dword v126, v174, s[52:55], 0 offen offset:4
    buffer_load_dword v127, v175, s[52:55], 0 offen offset:4
    ds_read_b128 v[196:199], v201 offset:512
    ds_read_b64_tr_b16 v[144:145], v202 offset:0
    ds_read_b64_tr_b16 v[146:147], v202 offset:64
    ds_read_b128 v[160:163], v204 offset:256
    ds_read_b128 v[164:167], v204 offset:288
    ds_read_b128 v[168:171], v204 offset:320
    ds_read_b128 v[172:175], v204 offset:352
    ds_read_b32 v253, v205 offset:512
    s_lshl_b32 s33, s3, 12
    s_add_u32 s33, s33, 131072
    v_add_u32 v139, s33, v139
    ds_read_b128 v[232:235], v139 offset:0
    ds_read_b128 v[236:239], v139 offset:1024
    ds_read_b128 v[240:243], v139 offset:2048
    ds_read_b128 v[244:247], v139 offset:3072
    v_and_b32 v224, 0xffff0000, v216
    v_lshlrev_b32 v216, 16, v216
    v_and_b32 v225, 0xffff0000, v217
    v_lshlrev_b32 v217, 16, v217
    v_and_b32 v226, 0xffff0000, v218
    v_lshlrev_b32 v218, 16, v218
    v_and_b32 v227, 0xffff0000, v219
    v_lshlrev_b32 v219, 16, v219
    v_and_b32 v228, 0xffff0000, v220
    v_lshlrev_b32 v220, 16, v220
    v_and_b32 v229, 0xffff0000, v221
    v_lshlrev_b32 v221, 16, v221
    v_and_b32 v230, 0xffff0000, v222
    v_lshlrev_b32 v222, 16, v222
    v_and_b32 v231, 0xffff0000, v223
    v_lshlrev_b32 v223, 16, v223
    s_waitcnt vmcnt(32)
    ds_write_b32 v248, v213
    ds_read_b32 v214, v215 offset:4
    ds_read_b128 v[192:195], v200
    v_add_u32 v213, v254, v213
    s_waitcnt lgkmcnt(0)
    v_cmp_gt_u32 vcc, v212, v214
    s_cbranch_vccnz E_slA0p
E_slA0pr:
    s_branch E_st1A
.p2align 6
E_loopA:
    v_cvt_pk_bf16_f32 v152, v152, v48
    v_cvt_pk_bf16_f32 v153, v153, v50
    v_cvt_pk_bf16_f32 v154, v154, v52
    v_cvt_pk_bf16_f32 v155, v155, v54
    v_cvt_pk_bf16_f32 v156, v156, v56
    v_cvt_pk_bf16_f32 v157, v157, v58
    v_cvt_pk_bf16_f32 v158, v158, v60
    v_cvt_pk_bf16_f32 v159, v159, v62
    v_exp_f32 v32, v32
    v_exp_f32 v33, v33
    v_smfmac_f32_32x32x32_bf16 v[16:31], v[144:147], v[152:159], v203
    v_exp_f32 v34, v34
    v_exp_f32 v35, v35
    v_exp_f32 v36, v36
    v_exp_f32 v37, v37
    v_exp_f32 v38, v38
    v_mfma_f32_32x32x16_bf16 v[48:63], v[192:195], v[180:183], 0
    v_exp_f32 v39, v39
    v_exp_f32 v40, v40
    v_exp_f32 v41, v41
    v_exp_f32 v42, v42
    v_exp_f32 v43, v43
    v_mfma_f32_32x32x16_bf16 v[48:63], v[196:199], v[188:191], v[48:63]
    v_exp_f32 v44, v44
    v_exp_f32 v45, v45
    v_exp_f32 v46, v46
    v_exp_f32 v47, v47
    buffer_load_dword v112, v160, s[52:55], 0 offen offset:4
    buffer_load_dword v113, v161, s[52:55], 0 offen offset:4
    buffer_load_dword v114, v162, s[52:55], 0 offen offset:4
    buffer_load_dword v115, v163, s[52:55], 0 offen offset:4
    buffer_load_dword v116, v164, s[52:55], 0 offen offset:4
    buffer_load_dword v117, v165, s[52:55], 0 offen offset:4
    buffer_load_dword v118, v166, s[52:55], 0 offen offset:4
    buffer_load_dword v119, v167, s[52:55], 0 offen offset:4
    s_waitcnt vmcnt(24)
    s_setprio 0
    v_add_f32 v32, 1.0, v32
    v_add_f32 v33, 1.0, v33
    v_add_f32 v34, 1.0, v34
    v_add_f32 v35, 1.0, v35
    v_add_f32 v36, 1.0, v36
    v_add_f32 v37, 1.0, v37
    v_add_f32 v38, 1.0, v38
    v_add_f32 v39, 1.0, v39
    v_add_f32 v40, 1.0, v40
    v_add_f32 v41, 1.0, v41
    v_add_f32 v42, 1.0, v42
    v_add_f32 v43, 1.0, v43
    v_add_f32 v44, 1.0, v44
    v_add_f32 v45, 1.0, v45
    v_add_f32 v46, 1.0, v46
    v_add_f32 v47, 1.0, v47
    v_add_u32 v213, v254, v213
    s_setprio 2
    v_rcp_f32 v32, v32
    v_rcp_f32 v33, v33
    v_smfmac_f32_32x32x32_bf16 v[48:63], v[128:131], v[80:87], v203 abid:1
    v_rcp_f32 v34, v34
    v_rcp_f32 v35, v35
    v_rcp_f32 v36, v36
    v_rcp_f32 v37, v37
    v_rcp_f32 v38, v38
    v_rcp_f32 v39, v39
    v_rcp_f32 v40, v40
    v_smfmac_f32_32x32x32_bf16 v[48:63], v[132:135], v[88:95], v203 abid:1
    v_rcp_f32 v41, v41
    v_rcp_f32 v42, v42
    v_rcp_f32 v43, v43
    v_rcp_f32 v44, v44
    v_rcp_f32 v45, v45
    v_rcp_f32 v46, v46
    v_rcp_f32 v47, v47
    buffer_load_dword v120, v168, s[52:55], 0 offen offset:4
    buffer_load_dword v121, v169, s[52:55], 0 offen offset:4
    buffer_load_dword v122, v170, s[52:55], 0 offen offset:4
    buffer_load_dword v123, v171, s[52:55], 0 offen offset:4
    buffer_load_dword v124, v172, s[52:55], 0 offen offset:4
    buffer_load_dword v125, v173, s[52:55], 0 offen offset:4
    buffer_load_dword v126, v174, s[52:55], 0 offen offset:4
    buffer_load_dword v127, v175, s[52:55], 0 offen offset:4
    ds_read_b32 v214, v215 offset:4
    ds_read_b128 v[192:195], v200
    ds_read_b128 v[196:199], v201 offset:512
    ds_read_b64_tr_b16 v[144:145], v202 offset:0
    ds_read_b64_tr_b16 v[146:147], v202 offset:64
    ds_read_b128 v[160:163], v204 offset:256
    ds_read_b128 v[164:167], v204 offset:288
    ds_read_b128 v[168:171], v204 offset:320
    ds_read_b128 v[172:175], v204 offset:352
    ds_read_b32 v253, v205 offset:512
    s_waitcnt lgkmcnt(0)
    v_cmp_gt_u32 vcc, v212, v214
    s_cbranch_vccnz E_slA0
E_slA0r:
    s_setprio 0
    v_add_f32 v152, v32, v33
    v_add_f32 v153, v34, v35
    v_add_f32 v154, v36, v37
    v_add_f32 v155, v38, v39
    v_add_f32 v156, v40, v41
    v_add_f32 v157, v42, v43
    v_add_f32 v158, v44, v45
    v_add_f32 v159, v46, v47
    v_mul_f32 v32, v32, v64
    v_mul_f32 v34, v34, v66
    v_mul_f32 v36, v36, v68
    v_mul_f32 v38, v38, v70
    v_mul_f32 v40, v40, v72
    v_mul_f32 v42, v42, v74
    v_mul_f32 v44, v44, v76
    v_mul_f32 v46, v46, v78
    v_fmac_f32 v32, v33, v65
    v_fmac_f32 v34, v35, v67
    v_fmac_f32 v36, v37, v69
    v_fmac_f32 v38, v39, v71
    v_fmac_f32 v40, v41, v73
    v_fmac_f32 v42, v43, v75
    v_fmac_f32 v44, v45, v77
    v_fmac_f32 v46, v47, v79
    s_setprio 2
E_st1A:
    v_cvt_pk_bf16_f32 v152, v152, v32
    v_cvt_pk_bf16_f32 v153, v153, v34
    v_cvt_pk_bf16_f32 v154, v154, v36
    v_cvt_pk_bf16_f32 v155, v155, v38
    v_cvt_pk_bf16_f32 v156, v156, v40
    v_cvt_pk_bf16_f32 v157, v157, v42
    v_cvt_pk_bf16_f32 v158, v158, v44
    v_cvt_pk_bf16_f32 v159, v159, v46
    v_exp_f32 v48, v48
    v_exp_f32 v49, v49
    v_smfmac_f32_32x32x32_bf16 v[0:15], v[144:147], v[152:159], v203
    v_exp_f32 v50, v50
    v_exp_f32 v51, v51
    v_exp_f32 v52, v52
    v_exp_f32 v53, v53
    v_exp_f32 v54, v54
    v_mfma_f32_32x32x16_bf16 v[32:47], v[192:195], v[176:179], 0
    v_exp_f32 v55, v55
    v_exp_f32 v56, v56
    v_exp_f32 v57, v57
    v_exp_f32 v58, v58
    v_exp_f32 v59, v59
    v_mfma_f32_32x32x16_bf16 v[32:47], v[196:199], v[184:187], v[32:47]
    v_exp_f32 v60, v60
    v_exp_f32 v61, v61
    v_exp_f32 v62, v62
    v_exp_f32 v63, v63
    buffer_load_dword v64, v160, s[52:55], 0 offen offset:0
    buffer_load_dword v65, v161, s[52:55], 0 offen offset:0
    s_cmp_lg_u32 s5, 1
    s_cbranch_scc1 E_ndA1
    s_add_u32 s21, s21, 2048
    s_and_b32 s21, s21, 0x1fff
    s_add_u32 s33, s20, s21
    s_mov_b32 m0, s33
    s_nop 0
    buffer_load_dwordx4 v207, s[56:59], 0 offen lds
E_ndA1:
    buffer_load_dword v66, v162, s[52:55], 0 offen offset:0
    buffer_load_dword v67, v163, s[52:55], 0 offen offset:0
    buffer_load_dword v68, v164, s[52:55], 0 offen offset:0
    buffer_load_dword v69, v165, s[52:55], 0 offen offset:0
    buffer_load_dword v70, v166, s[52:55], 0 offen offset:0
    buffer_load_dword v71, v167, s[52:55], 0 offen offset:0
    s_waitcnt vmcnt(24)
    ds_write_b32 v248, v213
    s_setprio 0
    v_add_u32 v251, 1024, v200
    v_add_f32 v48, 1.0, v48
    v_add_f32 v49, 1.0, v49
    v_add_f32 v50, 1.0, v50
    v_add_f32 v51, 1.0, v51
    v_add_f32 v52, 1.0, v52
    v_add_f32 v53, 1.0, v53
    v_add_f32 v54, 1.0, v54
    v_add_f32 v55, 1.0, v55
    v_add_f32 v56, 1.0, v56
    v_add_f32 v57, 1.0, v57
    v_add_f32 v58, 1.0, v58
    v_add_f32 v59, 1.0, v59
    v_add_f32 v60, 1.0, v60
    v_add_f32 v61, 1.0, v61
    v_add_f32 v62, 1.0, v62
    v_add_f32 v63, 1.0, v63
    v_and_b32 v208, 15, v253
    v_and_b32 v210, 0x3ff0, v253
    v_lshrrev_b32 v207, 15, v253
    v_add_u32 v207, v207, v206
    v_add_u32 v212, 1, v212
    v_bitop3_b32 v200, v249, v251, v200 bitop3:0xca
    s_setprio 2
    v_lshl_add_u32 v207, v208, 5, v207
    v_mad_u32_u24 v207, v210, s22, v207
    v_rcp_f32 v48, v48
    v_rcp_f32 v49, v49
    v_smfmac_f32_32x32x32_bf16 v[32:47], v[128:131], v[96:103], v203 abid:1
    v_rcp_f32 v50, v50
    v_rcp_f32 v51, v51
    v_rcp_f32 v52, v52
    v_rcp_f32 v53, v53
    v_rcp_f32 v54, v54
    v_rcp_f32 v55, v55
    v_rcp_f32 v56, v56
    v_smfmac_f32_32x32x32_bf16 v[32:47], v[132:135], v[104:111], v203 abid:1
    v_rcp_f32 v57, v57
    v_rcp_f32 v58, v58
    v_rcp_f32 v59, v59
    v_rcp_f32 v60, v60
    v_rcp_f32 v61, v61
    v_rcp_f32 v62, v62
    v_rcp_f32 v63, v63
    buffer_load_dword v72, v168, s[52:55], 0 offen offset:0
    buffer_load_dword v73, v169, s[52:55], 0 offen offset:0
    buffer_load_dword v74, v170, s[52:55], 0 offen offset:0
    buffer_load_dword v75, v171, s[52:55], 0 offen offset:0
    buffer_load_dword v76, v172, s[52:55], 0 offen offset:0
    buffer_load_dword v77, v173, s[52:55], 0 offen offset:0
    buffer_load_dword v78, v174, s[52:55], 0 offen offset:0
    buffer_load_dword v79, v175, s[52:55], 0 offen offset:0
    s_add_u32 s23, s23, 1
    s_cmp_lt_u32 s23, s96
    s_setprio 0
    v_add_f32 v152, v48, v49
    v_add_f32 v153, v50, v51
    v_add_f32 v154, v52, v53
    v_add_f32 v155, v54, v55
    v_add_f32 v156, v56, v57
    v_add_f32 v157, v58, v59
    v_add_f32 v158, v60, v61
    v_add_f32 v159, v62, v63
    v_mul_f32 v48, v48, v80
    v_mul_f32 v50, v50, v82
    v_mul_f32 v52, v52, v84
    v_mul_f32 v54, v54, v86
    v_mul_f32 v56, v56, v88
    v_mul_f32 v58, v58, v90
    v_mul_f32 v60, v60, v92
    v_mul_f32 v62, v62, v94
    v_fmac_f32 v48, v49, v81
    v_fmac_f32 v50, v51, v83
    v_fmac_f32 v52, v53, v85
    v_fmac_f32 v54, v55, v87
    v_fmac_f32 v56, v57, v89
    v_fmac_f32 v58, v59, v91
    v_fmac_f32 v60, v61, v93
    v_fmac_f32 v62, v63, v95
    s_setprio 2
    s_cbranch_scc0 E_fin
    v_cvt_pk_bf16_f32 v152, v152, v48
    v_cvt_pk_bf16_f32 v153, v153, v50
    v_cvt_pk_bf16_f32 v154, v154, v52
    v_cvt_pk_bf16_f32 v155, v155, v54
    v_cvt_pk_bf16_f32 v156, v156, v56
    v_cvt_pk_bf16_f32 v157, v157, v58
    v_cvt_pk_bf16_f32 v158, v158, v60
    v_cvt_pk_bf16_f32 v159, v159, v62
    v_exp_f32 v32, v32
    v_exp_f32 v33, v33
    v_smfmac_f32_32x32x32_bf16 v[16:31], v[144:147], v[152:159], v203
    v_exp_f32 v34, v34
    v_exp_f32 v35, v35
    v_exp_f32 v36, v36
    v_exp_f32 v37, v37
    v_exp_f32 v38, v38
    v_mfma_f32_32x32x16_bf16 v[48:63], v[192:195], v[180:183], 0
    v_exp_f32 v39, v39
    v_exp_f32 v40, v40
    v_exp_f32 v41, v41
    v_exp_f32 v42, v42
    v_exp_f32 v43, v43
    v_mfma_f32_32x32x16_bf16 v[48:63], v[196:199], v[188:191], v[48:63]
    v_exp_f32 v44, v44
    v_exp_f32 v45, v45
    v_exp_f32 v46, v46
    v_exp_f32 v47, v47
    buffer_load_dword v80, v160, s[52:55], 0 offen offset:4
    buffer_load_dword v81, v161, s[52:55], 0 offen offset:4
    buffer_load_dword v82, v162, s[52:55], 0 offen offset:4
    buffer_load_dword v83, v163, s[52:55], 0 offen offset:4
    buffer_load_dword v84, v164, s[52:55], 0 offen offset:4
    buffer_load_dword v85, v165, s[52:55], 0 offen offset:4
    buffer_load_dword v86, v166, s[52:55], 0 offen offset:4
    buffer_load_dword v87, v167, s[52:55], 0 offen offset:4
    s_waitcnt vmcnt(24)
    s_setprio 0
    v_add_f32 v32, 1.0, v32
    v_add_f32 v33, 1.0, v33
    v_add_f32 v34, 1.0, v34
    v_add_f32 v35, 1.0, v35
    v_add_f32 v36, 1.0, v36
    v_add_f32 v37, 1.0, v37
    v_add_f32 v38, 1.0, v38
    v_add_f32 v39, 1.0, v39
    v_add_f32 v40, 1.0, v40
    v_add_f32 v41, 1.0, v41
    v_add_f32 v42, 1.0, v42
    v_add_f32 v43, 1.0, v43
    v_add_f32 v44, 1.0, v44
    v_add_f32 v45, 1.0, v45
    v_add_f32 v46, 1.0, v46
    v_add_f32 v47, 1.0, v47
    v_add_u32 v213, v255, v213
    s_setprio 2
    v_rcp_f32 v32, v32
    v_rcp_f32 v33, v33
    v_smfmac_f32_32x32x32_bf16 v[48:63], v[128:131], v[112:119], v203 abid:1
    v_rcp_f32 v34, v34
    v_rcp_f32 v35, v35
    v_rcp_f32 v36, v36
    v_rcp_f32 v37, v37
    v_rcp_f32 v38, v38
    v_rcp_f32 v39, v39
    v_rcp_f32 v40, v40
    v_smfmac_f32_32x32x32_bf16 v[48:63], v[132:135], v[120:127], v203 abid:1
    v_rcp_f32 v41, v41
    v_rcp_f32 v42, v42
    v_rcp_f32 v43, v43
    v_rcp_f32 v44, v44
    v_rcp_f32 v45, v45
    v_rcp_f32 v46, v46
    v_rcp_f32 v47, v47
    buffer_load_dword v88, v168, s[52:55], 0 offen offset:4
    buffer_load_dword v89, v169, s[52:55], 0 offen offset:4
    buffer_load_dword v90, v170, s[52:55], 0 offen offset:4
    buffer_load_dword v91, v171, s[52:55], 0 offen offset:4
    buffer_load_dword v92, v172, s[52:55], 0 offen offset:4
    buffer_load_dword v93, v173, s[52:55], 0 offen offset:4
    buffer_load_dword v94, v174, s[52:55], 0 offen offset:4
    buffer_load_dword v95, v175, s[52:55], 0 offen offset:4
    ds_read_b32 v214, v215 offset:0
    ds_read_b128 v[192:195], v200
    ds_read_b128 v[196:199], v201 offset:1024
    ds_read_b64_tr_b16 v[144:145], v202 offset:512
    ds_read_b64_tr_b16 v[146:147], v202 offset:576
    ds_read_b128 v[160:163], v204 offset:384
    ds_read_b128 v[164:167], v204 offset:416
    ds_read_b128 v[168:171], v204 offset:448
    ds_read_b128 v[172:175], v204 offset:480
    s_waitcnt lgkmcnt(0)
    v_cmp_gt_u32 vcc, v212, v214
    s_cbranch_vccnz E_slA1
E_slA1r:
    s_setprio 0
    v_add_f32 v152, v32, v33
    v_add_f32 v153, v34, v35
    v_add_f32 v154, v36, v37
    v_add_f32 v155, v38, v39
    v_add_f32 v156, v40, v41
    v_add_f32 v157, v42, v43
    v_add_f32 v158, v44, v45
    v_add_f32 v159, v46, v47
    v_mul_f32 v32, v32, v96
    v_mul_f32 v34, v34, v98
    v_mul_f32 v36, v36, v100
    v_mul_f32 v38, v38, v102
    v_mul_f32 v40, v40, v104
    v_mul_f32 v42, v42, v106
    v_mul_f32 v44, v44, v108
    v_mul_f32 v46, v46, v110
    v_fmac_f32 v32, v33, v97
    v_fmac_f32 v34, v35, v99
    v_fmac_f32 v36, v37, v101
    v_fmac_f32 v38, v39, v103
    v_fmac_f32 v40, v41, v105
    v_fmac_f32 v42, v43, v107
    v_fmac_f32 v44, v45, v109
    v_fmac_f32 v46, v47, v111
    s_setprio 2
    v_cvt_pk_bf16_f32 v152, v152, v32
    v_cvt_pk_bf16_f32 v153, v153, v34
    v_cvt_pk_bf16_f32 v154, v154, v36
    v_cvt_pk_bf16_f32 v155, v155, v38
    v_cvt_pk_bf16_f32 v156, v156, v40
    v_cvt_pk_bf16_f32 v157, v157, v42
    v_cvt_pk_bf16_f32 v158, v158, v44
    v_cvt_pk_bf16_f32 v159, v159, v46
    v_exp_f32 v48, v48
    v_exp_f32 v49, v49
    v_smfmac_f32_32x32x32_bf16 v[0:15], v[144:147], v[152:159], v203
    v_exp_f32 v50, v50
    v_exp_f32 v51, v51
    v_exp_f32 v52, v52
    v_exp_f32 v53, v53
    v_exp_f32 v54, v54
    v_mfma_f32_32x32x16_bf16 v[32:47], v[192:195], v[176:179], 0
    v_exp_f32 v55, v55
    v_exp_f32 v56, v56
    v_exp_f32 v57, v57
    v_exp_f32 v58, v58
    v_exp_f32 v59, v59
    v_mfma_f32_32x32x16_bf16 v[32:47], v[196:199], v[184:187], v[32:47]
    v_exp_f32 v60, v60
    v_exp_f32 v61, v61
    v_exp_f32 v62, v62
    v_exp_f32 v63, v63
    buffer_load_dword v96, v160, s[52:55], 0 offen offset:0
    buffer_load_dword v97, v161, s[52:55], 0 offen offset:0
    s_cmp_lg_u32 s5, 0
    s_cbranch_scc1 E_ndA3
    s_add_u32 s21, s21, 2048
    s_and_b32 s21, s21, 0x1fff
    s_add_u32 s33, s20, s21
    s_mov_b32 m0, s33
    s_nop 0
    buffer_load_dwordx4 v207, s[56:59], 0 offen lds
E_ndA3:
    buffer_load_dword v98, v162, s[52:55], 0 offen offset:0
    buffer_load_dword v99, v163, s[52:55], 0 offen offset:0
    buffer_load_dword v100, v164, s[52:55], 0 offen offset:0
    buffer_load_dword v101, v165, s[52:55], 0 offen offset:0
    buffer_load_dword v102, v166, s[52:55], 0 offen offset:0
    buffer_load_dword v103, v167, s[52:55], 0 offen offset:0
    s_waitcnt vmcnt(24)
    ds_write_b32 v248, v213
    s_setprio 0
    v_add_f32 v48, 1.0, v48
    v_add_f32 v49, 1.0, v49
    v_add_f32 v50, 1.0, v50
    v_add_f32 v51, 1.0, v51
    v_add_f32 v52, 1.0, v52
    v_add_f32 v53, 1.0, v53
    v_add_f32 v54, 1.0, v54
    v_add_f32 v55, 1.0, v55
    v_add_f32 v56, 1.0, v56
    v_add_f32 v57, 1.0, v57
    v_add_f32 v58, 1.0, v58
    v_add_f32 v59, 1.0, v59
    v_add_f32 v60, 1.0, v60
    v_add_f32 v61, 1.0, v61
    v_add_f32 v62, 1.0, v62
    v_add_f32 v63, 1.0, v63
    v_add_u32 v201, 1024, v201
    v_add_u32 v202, 1024, v202
    v_add_u32 v204, 256, v204
    v_add_u32 v205, 256, v205
    v_add_u32 v200, 1024, v200
    v_add_u32 v212, 1, v212
    s_setprio 2
    v_rcp_f32 v48, v48
    v_rcp_f32 v49, v49
    v_smfmac_f32_32x32x32_bf16 v[32:47], v[128:131], v[64:71], v203 abid:1
    v_rcp_f32 v50, v50
    v_rcp_f32 v51, v51
    v_rcp_f32 v52, v52
    v_rcp_f32 v53, v53
    v_rcp_f32 v54, v54
    v_rcp_f32 v55, v55
    v_rcp_f32 v56, v56
    v_smfmac_f32_32x32x32_bf16 v[32:47], v[132:135], v[72:79], v203 abid:1
    v_rcp_f32 v57, v57
    v_rcp_f32 v58, v58
    v_rcp_f32 v59, v59
    v_rcp_f32 v60, v60
    v_rcp_f32 v61, v61
    v_rcp_f32 v62, v62
    v_rcp_f32 v63, v63
    buffer_load_dword v104, v168, s[52:55], 0 offen offset:0
    buffer_load_dword v105, v169, s[52:55], 0 offen offset:0
    buffer_load_dword v106, v170, s[52:55], 0 offen offset:0
    buffer_load_dword v107, v171, s[52:55], 0 offen offset:0
    buffer_load_dword v108, v172, s[52:55], 0 offen offset:0
    buffer_load_dword v109, v173, s[52:55], 0 offen offset:0
    buffer_load_dword v110, v174, s[52:55], 0 offen offset:0
    buffer_load_dword v111, v175, s[52:55], 0 offen offset:0
    s_add_u32 s23, s23, 1
    s_cmp_lt_u32 s23, s96
    s_setprio 0
    v_add_f32 v152, v48, v49
    v_add_f32 v153, v50, v51
    v_add_f32 v154, v52, v53
    v_add_f32 v155, v54, v55
    v_add_f32 v156, v56, v57
    v_add_f32 v157, v58, v59
    v_add_f32 v158, v60, v61
    v_add_f32 v159, v62, v63
    v_mul_f32 v48, v48, v112
    v_mul_f32 v50, v50, v114
    v_mul_f32 v52, v52, v116
    v_mul_f32 v54, v54, v118
    v_mul_f32 v56, v56, v120
    v_mul_f32 v58, v58, v122
    v_mul_f32 v60, v60, v124
    v_mul_f32 v62, v62, v126
    v_fmac_f32 v48, v49, v113
    v_fmac_f32 v50, v51, v115
    v_fmac_f32 v52, v53, v117
    v_fmac_f32 v54, v55, v119
    v_fmac_f32 v56, v57, v121
    v_fmac_f32 v58, v59, v123
    v_fmac_f32 v60, v61, v125
    v_fmac_f32 v62, v63, v127
    s_setprio 2
    s_cbranch_scc1 E_loopA
    s_branch E_fin
E_entB:
    s_setprio 1
    s_cmp_eq_u32 s5, 0
    s_cbranch_scc1 E_d1B
    buffer_load_dwordx4 v207, s[56:59], 0 offen lds
    buffer_load_dword v96, v160, s[52:55], 0 offen
    buffer_load_dword v97, v161, s[52:55], 0 offen
    buffer_load_dword v98, v162, s[52:55], 0 offen
    buffer_load_dword v99, v163, s[52:55], 0 offen
    buffer_load_dword v100, v164, s[52:55], 0 offen
    buffer_load_dword v101, v165, s[52:55], 0 offen
    buffer_load_dword v102, v166, s[52:55], 0 offen
    buffer_load_dword v103, v167, s[52:55], 0 offen
    buffer_load_dword v104, v168, s[52:55], 0 offen
    buffer_load_dword v105, v169, s[52:55], 0 offen
    buffer_load_dword v106, v170, s[52:55], 0 offen
    buffer_load_dword v107, v171, s[52:55], 0 offen
    buffer_load_dword v108, v172, s[52:55], 0 offen
    buffer_load_dword v109, v173, s[52:55], 0 offen
    buffer_load_dword v110, v174, s[52:55], 0 offen
    buffer_load_dword v111, v175, s[52:55], 0 offen
    s_branch E_d2B
E_d1B:
    s_add_u32 s21, s21, 2048
    s_add_u32 s33, s20, s21
    s_mov_b32 m0, s33
    buffer_load_dword v96, v160, s[52:55], 0 offen
    buffer_load_dword v97, v161, s[52:55], 0 offen
    buffer_load_dword v98, v162, s[52:55], 0 offen
    buffer_load_dword v99, v163, s[52:55], 0 offen
    buffer_load_dword v100, v164, s[52:55], 0 offen
    buffer_load_dword v101, v165, s[52:55], 0 offen
    buffer_load_dword v102, v166, s[52:55], 0 offen
    buffer_load_dword v103, v167, s[52:55], 0 offen
    buffer_load_dwordx4 v253, s[56:59], 0 offen lds
    buffer_load_dword v104, v168, s[52:55], 0 offen
    buffer_load_dword v105, v169, s[52:55], 0 offen
    buffer_load_dword v106, v170, s[52:55], 0 offen
    buffer_load_dword v107, v171, s[52:55], 0 offen
    buffer_load_dword v108, v172, s[52:55], 0 offen
    buffer_load_dword v109, v173, s[52:55], 0 offen
    buffer_load_dword v110, v174, s[52:55], 0 offen
    buffer_load_dword v111, v175, s[52:55], 0 offen
E_d2B:
    v_mov_b32 v207, v253
    v_exp_f32 v32, v32
    v_exp_f32 v33, v33
    v_exp_f32 v34, v34
    v_exp_f32 v35, v35
    v_exp_f32 v36, v36
    v_exp_f32 v37, v37
    v_exp_f32 v38, v38
    v_mfma_f32_32x32x16_bf16 v[48:63], v[192:195], v[180:183], 0
    v_exp_f32 v39, v39
    v_exp_f32 v40, v40
    v_exp_f32 v41, v41
    v_exp_f32 v42, v42
    v_exp_f32 v43, v43
    v_mfma_f32_32x32x16_bf16 v[48:63], v[196:199], v[188:191], v[48:63]
    v_exp_f32 v44, v44
    v_exp_f32 v45, v45
    v_exp_f32 v46, v46
    v_exp_f32 v47, v47
    v_add_f32 v32, 1.0, v32
    v_add_f32 v33, 1.0, v33
    v_add_f32 v34, 1.0, v34
    v_add_f32 v35, 1.0, v35
    v_add_f32 v36, 1.0, v36
    v_add_f32 v37, 1.0, v37
    v_add_f32 v38, 1.0, v38
    v_add_f32 v39, 1.0, v39
    v_add_f32 v40, 1.0, v40
    v_add_f32 v41, 1.0, v41
    v_add_f32 v42, 1.0, v42
    v_add_f32 v43, 1.0, v43
    v_add_f32 v44, 1.0, v44
    v_add_f32 v45, 1.0, v45
    v_add_f32 v46, 1.0, v46
    v_add_f32 v47, 1.0, v47
    s_waitcnt vmcnt(17)
    v_rcp_f32 v32, v32
    v_rcp_f32 v33, v33
    v_smfmac_f32_32x32x32_bf16 v[48:63], v[128:131], v[80:87], v203 abid:1
    v_rcp_f32 v34, v34
    v_rcp_f32 v35, v35
    v_rcp_f32 v36, v36
    v_rcp_f32 v37, v37
    v_rcp_f32 v38, v38
    v_rcp_f32 v39, v39
    v_rcp_f32 v40, v40
    v_smfmac_f32_32x32x32_bf16 v[48:63], v[132:135], v[88:95], v203 abid:1
    v_rcp_f32 v41, v41
    v_rcp_f32 v42, v42
    v_rcp_f32 v43, v43
    v_rcp_f32 v44, v44
    v_rcp_f32 v45, v45
    v_rcp_f32 v46, v46
    v_rcp_f32 v47, v47
    v_add_f32 v152, v32, v33
    v_add_f32 v153, v34, v35
    v_add_f32 v154, v36, v37
    v_add_f32 v155, v38, v39
    v_add_f32 v156, v40, v41
    v_add_f32 v157, v42, v43
    v_add_f32 v158, v44, v45
    v_add_f32 v159, v46, v47
    v_mul_f32 v32, v32, v64
    v_mul_f32 v34, v34, v66
    v_mul_f32 v36, v36, v68
    v_mul_f32 v38, v38, v70
    v_mul_f32 v40, v40, v72
    v_mul_f32 v42, v42, v74
    v_mul_f32 v44, v44, v76
    v_mul_f32 v46, v46, v78
    v_fmac_f32 v32, v33, v65
    v_fmac_f32 v34, v35, v67
    v_fmac_f32 v36, v37, v69
    v_fmac_f32 v38, v39, v71
    v_fmac_f32 v40, v41, v73
    v_fmac_f32 v42, v43, v75
    v_fmac_f32 v44, v45, v77
    v_fmac_f32 v46, v47, v79
    buffer_load_dword v112, v160, s[52:55], 0 offen offset:4
    buffer_load_dword v113, v161, s[52:55], 0 offen offset:4
    buffer_load_dword v114, v162, s[52:55], 0 offen offset:4
    buffer_load_dword v115, v163, s[52:55], 0 offen offset:4
    buffer_load_dword v116, v164, s[52:55], 0 offen offset:4
    buffer_load_dword v117, v165, s[52:55], 0 offen offset:4
    buffer_load_dword v118, v166, s[52:55], 0 offen offset:4
    buffer_load_dword v119, v167, s[52:55], 0 offen offset:4
    buffer_load_dword v120, v168, s[52:55], 0 offen offset:4
    buffer_load_dword v121, v169, s[52:55], 0 offen offset:4
    buffer_load_dword v122, v170, s[52:55], 0 offen offset:4
    buffer_load_dword v123, v171, s[52:55], 0 offen offset:4
    buffer_load_dword v124, v172, s[52:55], 0 offen offset:4
    buffer_load_dword v125, v173, s[52:55], 0 offen offset:4
    buffer_load_dword v126, v174, s[52:55], 0 offen offset:4
    buffer_load_dword v127, v175, s[52:55], 0 offen offset:4
    ds_read_b128 v[196:199], v201 offset:512
    ds_read_b64_tr_b16 v[144:145], v202 offset:0
    ds_read_b64_tr_b16 v[146:147], v202 offset:64
    ds_read_b128 v[160:163], v204 offset:256
    ds_read_b128 v[164:167], v204 offset:288
    ds_read_b128 v[168:171], v204 offset:320
    ds_read_b128 v[172:175], v204 offset:352
    ds_read_b32 v253, v205 offset:512
    s_lshl_b32 s33, s3, 12
    s_add_u32 s33, s33, 131072
    v_add_u32 v139, s33, v139
    ds_read_b128 v[232:235], v139 offset:0
    ds_read_b128 v[236:239], v139 offset:1024
    ds_read_b128 v[240:243], v139 offset:2048
    ds_read_b128 v[244:247], v139 offset:3072
    v_and_b32 v224, 0xffff0000, v216
    v_lshlrev_b32 v216, 16, v216
    v_and_b32 v225, 0xffff0000, v217
    v_lshlrev_b32 v217, 16, v217
    v_and_b32 v226, 0xffff0000, v218
    v_lshlrev_b32 v218, 16, v218
    v_and_b32 v227, 0xffff0000, v219
    v_lshlrev_b32 v219, 16, v219
    v_and_b32 v228, 0xffff0000, v220
    v_lshlrev_b32 v220, 16, v220
    v_and_b32 v229, 0xffff0000, v221
    v_lshlrev_b32 v221, 16, v221
    v_and_b32 v230, 0xffff0000, v222
    v_lshlrev_b32 v222, 16, v222
    v_and_b32 v231, 0xffff0000, v223
    v_lshlrev_b32 v223, 16, v223
    s_waitcnt vmcnt(32)
    ds_write_b32 v248, v213
    ds_read_b32 v214, v215 offset:4
    ds_read_b128 v[192:195], v200
    v_add_u32 v213, v254, v213
    s_waitcnt lgkmcnt(0)
    s_setprio 3
    v_cmp_gt_u32 vcc, v212, v214
    s_setprio 1
    s_cbranch_vccnz E_slB0p
E_slB0pr:
    s_branch E_st1B
.p2align 6
E_loopB:
    buffer_load_dword v112, v160, s[52:55], 0 offen offset:4
    buffer_load_dword v113, v161, s[52:55], 0 offen offset:4
    buffer_load_dword v114, v162, s[52:55], 0 offen offset:4
    buffer_load_dword v115, v163, s[52:55], 0 offen offset:4
    buffer_load_dword v116, v164, s[52:55], 0 offen offset:4
    buffer_load_dword v117, v165, s[52:55], 0 offen offset:4
    buffer_load_dword v118, v166, s[52:55], 0 offen offset:4
    buffer_load_dword v119, v167, s[52:55], 0 offen offset:4
    v_cvt_pk_bf16_f32 v152, v152, v48
    v_cvt_pk_bf16_f32 v153, v153, v50
    v_cvt_pk_bf16_f32 v154, v154, v52
    v_cvt_pk_bf16_f32 v155, v155, v54
    v_cvt_pk_bf16_f32 v156, v156, v56
    v_cvt_pk_bf16_f32 v157, v157, v58
    v_cvt_pk_bf16_f32 v158, v158, v60
    v_cvt_pk_bf16_f32 v159, v159, v62
    v_exp_f32 v32, v32
    v_exp_f32 v33, v33
    v_smfmac_f32_32x32x32_bf16 v[16:31], v[144:147], v[152:159], v203
    v_exp_f32 v34, v34
    v_exp_f32 v35, v35
    v_exp_f32 v36, v36
    v_exp_f32 v37, v37
    v_exp_f32 v38, v38
    v_mfma_f32_32x32x16_bf16 v[48:63], v[192:195], v[180:183], 0
    v_exp_f32 v39, v39
    v_exp_f32 v40, v40
    v_exp_f32 v41, v41
    v_exp_f32 v42, v42
    v_exp_f32 v43, v43
    v_mfma_f32_32x32x16_bf16 v[48:63], v[196:199], v[188:191], v[48:63]
    v_exp_f32 v44, v44
    v_exp_f32 v45, v45
    v_exp_f32 v46, v46
    v_exp_f32 v47, v47
    s_setprio 3
    v_add_f32 v32, 1.0, v32
    v_add_f32 v33, 1.0, v33
    v_add_f32 v34, 1.0, v34
    v_add_f32 v35, 1.0, v35
    v_add_f32 v36, 1.0, v36
    v_add_f32 v37, 1.0, v37
    v_add_f32 v38, 1.0, v38
    v_add_f32 v39, 1.0, v39
    v_add_f32 v40, 1.0, v40
    v_add_f32 v41, 1.0, v41
    v_add_f32 v42, 1.0, v42
    v_add_f32 v43, 1.0, v43
    v_add_f32 v44, 1.0, v44
    v_add_f32 v45, 1.0, v45
    v_add_f32 v46, 1.0, v46
    v_add_f32 v47, 1.0, v47
    v_add_u32 v213, v254, v213
    s_setprio 1
    buffer_load_dword v120, v168, s[52:55], 0 offen offset:4
    buffer_load_dword v121, v169, s[52:55], 0 offen offset:4
    buffer_load_dword v122, v170, s[52:55], 0 offen offset:4
    buffer_load_dword v123, v171, s[52:55], 0 offen offset:4
    buffer_load_dword v124, v172, s[52:55], 0 offen offset:4
    buffer_load_dword v125, v173, s[52:55], 0 offen offset:4
    buffer_load_dword v126, v174, s[52:55], 0 offen offset:4
    buffer_load_dword v127, v175, s[52:55], 0 offen offset:4
    ds_read_b32 v214, v215 offset:4
    ds_read_b128 v[192:195], v200
    ds_read_b128 v[196:199], v201 offset:512
    ds_read_b64_tr_b16 v[144:145], v202 offset:0
    ds_read_b64_tr_b16 v[146:147], v202 offset:64
    ds_read_b128 v[160:163], v204 offset:256
    ds_read_b128 v[164:167], v204 offset:288
    ds_read_b128 v[168:171], v204 offset:320
    ds_read_b128 v[172:175], v204 offset:352
    ds_read_b32 v253, v205 offset:512
    s_waitcnt vmcnt(32)
    v_rcp_f32 v32, v32
    v_rcp_f32 v33, v33
    v_smfmac_f32_32x32x32_bf16 v[48:63], v[128:131], v[80:87], v203 abid:1
    v_rcp_f32 v34, v34
    v_rcp_f32 v35, v35
    v_rcp_f32 v36, v36
    v_rcp_f32 v37, v37
    v_rcp_f32 v38, v38
    v_rcp_f32 v39, v39
    v_rcp_f32 v40, v40
    v_smfmac_f32_32x32x32_bf16 v[48:63], v[132:135], v[88:95], v203 abid:1
    v_rcp_f32 v41, v41
    v_rcp_f32 v42, v42
    v_rcp_f32 v43, v43
    v_rcp_f32 v44, v44
    v_rcp_f32 v45, v45
    v_rcp_f32 v46, v46
    v_rcp_f32 v47, v47
    s_setprio 3
    v_add_f32 v152, v32, v33
    v_add_f32 v153, v34, v35
    v_add_f32 v154, v36, v37
    v_add_f32 v155, v38, v39
    v_add_f32 v156, v40, v41
    v_add_f32 v157, v42, v43
    v_add_f32 v158, v44, v45
    v_add_f32 v159, v46, v47
    v_mul_f32 v32, v32, v64
    v_mul_f32 v34, v34, v66
    v_mul_f32 v36, v36, v68
    v_mul_f32 v38, v38, v70
    v_mul_f32 v40, v40, v72
    v_mul_f32 v42, v42, v74
    v_mul_f32 v44, v44, v76
    v_mul_f32 v46, v46, v78
    v_fmac_f32 v32, v33, v65
    v_fmac_f32 v34, v35, v67
    v_fmac_f32 v36, v37, v69
    v_fmac_f32 v38, v39, v71
    v_fmac_f32 v40, v41, v73
    v_fmac_f32 v42, v43, v75
    v_fmac_f32 v44, v45, v77
    v_fmac_f32 v46, v47, v79
    s_setprio 1
E_st1B:
    s_waitcnt lgkmcnt(0)
    buffer_load_dword v64, v160, s[52:55], 0 offen offset:0
    buffer_load_dword v65, v161, s[52:55], 0 offen offset:0
    s_cmp_lg_u32 s5, 1
    s_cbranch_scc1 E_ndB1
    s_add_u32 s21, s21, 2048
    s_and_b32 s21, s21, 0x1fff
    s_add_u32 s33, s20, s21
    s_mov_b32 m0, s33
    s_nop 0
    buffer_load_dwordx4 v207, s[56:59], 0 offen lds
E_ndB1:
    buffer_load_dword v66, v162, s[52:55], 0 offen offset:0
    buffer_load_dword v67, v163, s[52:55], 0 offen offset:0
    buffer_load_dword v68, v164, s[52:55], 0 offen offset:0
    buffer_load_dword v69, v165, s[52:55], 0 offen offset:0
    buffer_load_dword v70, v166, s[52:55], 0 offen offset:0
    buffer_load_dword v71, v167, s[52:55], 0 offen offset:0
    s_setprio 3
    v_cmp_gt_u32 vcc, v212, v214
    s_setprio 1
    s_cbranch_vccnz E_slB0
E_slB0r:
    v_cvt_pk_bf16_f32 v152, v152, v32
    v_cvt_pk_bf16_f32 v153, v153, v34
    v_cvt_pk_bf16_f32 v154, v154, v36
    v_cvt_pk_bf16_f32 v155, v155, v38
    v_cvt_pk_bf16_f32 v156, v156, v40
    v_cvt_pk_bf16_f32 v157, v157, v42
    v_cvt_pk_bf16_f32 v158, v158, v44
    v_cvt_pk_bf16_f32 v159, v159, v46
    v_exp_f32 v48, v48
    v_exp_f32 v49, v49
    v_smfmac_f32_32x32x32_bf16 v[0:15], v[144:147], v[152:159], v203
    v_exp_f32 v50, v50
    v_exp_f32 v51, v51
    v_exp_f32 v52, v52
    v_exp_f32 v53, v53
    v_exp_f32 v54, v54
    v_mfma_f32_32x32x16_bf16 v[32:47], v[192:195], v[176:179], 0
    v_exp_f32 v55, v55
    v_exp_f32 v56, v56
    v_exp_f32 v57, v57
    v_exp_f32 v58, v58
    v_exp_f32 v59, v59
    v_mfma_f32_32x32x16_bf16 v[32:47], v[196:199], v[184:187], v[32:47]
    v_exp_f32 v60, v60
    v_exp_f32 v61, v61
    v_exp_f32 v62, v62
    v_exp_f32 v63, v63
    s_setprio 3
    v_add_u32 v251, 1024, v200
    v_add_f32 v48, 1.0, v48
    v_add_f32 v49, 1.0, v49
    v_add_f32 v50, 1.0, v50
    v_add_f32 v51, 1.0, v51
    v_add_f32 v52, 1.0, v52
    v_add_f32 v53, 1.0, v53
    v_add_f32 v54, 1.0, v54
    v_add_f32 v55, 1.0, v55
    v_add_f32 v56, 1.0, v56
    v_add_f32 v57, 1.0, v57
    v_add_f32 v58, 1.0, v58
    v_add_f32 v59, 1.0, v59
    v_add_f32 v60, 1.0, v60
    v_add_f32 v61, 1.0, v61
    v_add_f32 v62, 1.0, v62
    v_add_f32 v63, 1.0, v63
    v_and_b32 v208, 15, v253
    v_and_b32 v210, 0x3ff0, v253
    v_lshrrev_b32 v207, 15, v253
    v_add_u32 v207, v207, v206
    v_add_u32 v212, 1, v212
    v_bitop3_b32 v200, v249, v251, v200 bitop3:0xca
    s_setprio 1
    buffer_load_dword v72, v168, s[52:55], 0 offen offset:0
    buffer_load_dword v73, v169, s[52:55], 0 offen offset:0
    buffer_load_dword v74, v170, s[52:55], 0 offen offset:0
    buffer_load_dword v75, v171, s[52:55], 0 offen offset:0
    buffer_load_dword v76, v172, s[52:55], 0 offen offset:0
    buffer_load_dword v77, v173, s[52:55], 0 offen offset:0
    buffer_load_dword v78, v174, s[52:55], 0 offen offset:0
    buffer_load_dword v79, v175, s[52:55], 0 offen offset:0
    s_add_u32 s23, s23, 1
    s_cmp_lt_u32 s23, s96
    s_waitcnt vmcnt(32)
    ds_write_b32 v248, v213
    v_lshl_add_u32 v207, v208, 5, v207
    v_mad_u32_u24 v207, v210, s22, v207
    v_rcp_f32 v48, v48
    v_rcp_f32 v49, v49
    v_smfmac_f32_32x32x32_bf16 v[32:47], v[128:131], v[96:103], v203 abid:1
    v_rcp_f32 v50, v50
    v_rcp_f32 v51, v51
    v_rcp_f32 v52, v52
    v_rcp_f32 v53, v53
    v_rcp_f32 v54, v54
    v_rcp_f32 v55, v55
    v_rcp_f32 v56, v56
    v_smfmac_f32_32x32x32_bf16 v[32:47], v[132:135], v[104:111], v203 abid:1
    v_rcp_f32 v57, v57
    v_rcp_f32 v58, v58
    v_rcp_f32 v59, v59
    v_rcp_f32 v60, v60
    v_rcp_f32 v61, v61
    v_rcp_f32 v62, v62
    v_rcp_f32 v63, v63
    s_setprio 3
    v_add_f32 v152, v48, v49
    v_add_f32 v153, v50, v51
    v_add_f32 v154, v52, v53
    v_add_f32 v155, v54, v55
    v_add_f32 v156, v56, v57
    v_add_f32 v157, v58, v59
    v_add_f32 v158, v60, v61
    v_add_f32 v159, v62, v63
    v_mul_f32 v48, v48, v80
    v_mul_f32 v50, v50, v82
    v_mul_f32 v52, v52, v84
    v_mul_f32 v54, v54, v86
    v_mul_f32 v56, v56, v88
    v_mul_f32 v58, v58, v90
    v_mul_f32 v60, v60, v92
    v_mul_f32 v62, v62, v94
    v_fmac_f32 v48, v49, v81
    v_fmac_f32 v50, v51, v83
    v_fmac_f32 v52, v53, v85
    v_fmac_f32 v54, v55, v87
    v_fmac_f32 v56, v57, v89
    v_fmac_f32 v58, v59, v91
    v_fmac_f32 v60, v61, v93
    v_fmac_f32 v62, v63, v95
    s_setprio 1
    s_cbranch_scc0 E_fin
    buffer_load_dword v80, v160, s[52:55], 0 offen offset:4
    buffer_load_dword v81, v161, s[52:55], 0 offen offset:4
    buffer_load_dword v82, v162, s[52:55], 0 offen offset:4
    buffer_load_dword v83, v163, s[52:55], 0 offen offset:4
    buffer_load_dword v84, v164, s[52:55], 0 offen offset:4
    buffer_load_dword v85, v165, s[52:55], 0 offen offset:4
    buffer_load_dword v86, v166, s[52:55], 0 offen offset:4
    buffer_load_dword v87, v167, s[52:55], 0 offen offset:4
    v_cvt_pk_bf16_f32 v152, v152, v48
    v_cvt_pk_bf16_f32 v153, v153, v50
    v_cvt_pk_bf16_f32 v154, v154, v52
    v_cvt_pk_bf16_f32 v155, v155, v54
    v_cvt_pk_bf16_f32 v156, v156, v56
    v_cvt_pk_bf16_f32 v157, v157, v58
    v_cvt_pk_bf16_f32 v158, v158, v60
    v_cvt_pk_bf16_f32 v159, v159, v62
    v_exp_f32 v32, v32
    v_exp_f32 v33, v33
    v_smfmac_f32_32x32x32_bf16 v[16:31], v[144:147], v[152:159], v203
    v_exp_f32 v34, v34
    v_exp_f32 v35, v35
    v_exp_f32 v36, v36
    v_exp_f32 v37, v37
    v_exp_f32 v38, v38
    v_mfma_f32_32x32x16_bf16 v[48:63], v[192:195], v[180:183], 0
    v_exp_f32 v39, v39
    v_exp_f32 v40, v40
    v_exp_f32 v41, v41
    v_exp_f32 v42, v42
    v_exp_f32 v43, v43
    v_mfma_f32_32x32x16_bf16 v[48:63], v[196:199], v[188:191], v[48:63]
    v_exp_f32 v44, v44
    v_exp_f32 v45, v45
    v_exp_f32 v46, v46
    v_exp_f32 v47, v47
    s_setprio 3
    v_add_f32 v32, 1.0, v32
    v_add_f32 v33, 1.0, v33
    v_add_f32 v34, 1.0, v34
    v_add_f32 v35, 1.0, v35
    v_add_f32 v36, 1.0, v36
    v_add_f32 v37, 1.0, v37
    v_add_f32 v38, 1.0, v38
    v_add_f32 v39, 1.0, v39
    v_add_f32 v40, 1.0, v40
    v_add_f32 v41, 1.0, v41
    v_add_f32 v42, 1.0, v42
    v_add_f32 v43, 1.0, v43
    v_add_f32 v44, 1.0, v44
    v_add_f32 v45, 1.0, v45
    v_add_f32 v46, 1.0, v46
    v_add_f32 v47, 1.0, v47
    v_add_u32 v213, v255, v213
    s_setprio 1
    buffer_load_dword v88, v168, s[52:55], 0 offen offset:4
    buffer_load_dword v89, v169, s[52:55], 0 offen offset:4
    buffer_load_dword v90, v170, s[52:55], 0 offen offset:4
    buffer_load_dword v91, v171, s[52:55], 0 offen offset:4
    buffer_load_dword v92, v172, s[52:55], 0 offen offset:4
    buffer_load_dword v93, v173, s[52:55], 0 offen offset:4
    buffer_load_dword v94, v174, s[52:55], 0 offen offset:4
    buffer_load_dword v95, v175, s[52:55], 0 offen offset:4
    ds_read_b32 v214, v215 offset:0
    ds_read_b128 v[192:195], v200
    ds_read_b128 v[196:199], v201 offset:1024
    ds_read_b64_tr_b16 v[144:145], v202 offset:512
    ds_read_b64_tr_b16 v[146:147], v202 offset:576
    ds_read_b128 v[160:163], v204 offset:384
    ds_read_b128 v[164:167], v204 offset:416
    ds_read_b128 v[168:171], v204 offset:448
    ds_read_b128 v[172:175], v204 offset:480
    s_waitcnt vmcnt(32)
    v_rcp_f32 v32, v32
    v_rcp_f32 v33, v33
    v_smfmac_f32_32x32x32_bf16 v[48:63], v[128:131], v[112:119], v203 abid:1
    v_rcp_f32 v34, v34
    v_rcp_f32 v35, v35
    v_rcp_f32 v36, v36
    v_rcp_f32 v37, v37
    v_rcp_f32 v38, v38
    v_rcp_f32 v39, v39
    v_rcp_f32 v40, v40
    v_smfmac_f32_32x32x32_bf16 v[48:63], v[132:135], v[120:127], v203 abid:1
    v_rcp_f32 v41, v41
    v_rcp_f32 v42, v42
    v_rcp_f32 v43, v43
    v_rcp_f32 v44, v44
    v_rcp_f32 v45, v45
    v_rcp_f32 v46, v46
    v_rcp_f32 v47, v47
    s_setprio 3
    v_add_f32 v152, v32, v33
    v_add_f32 v153, v34, v35
    v_add_f32 v154, v36, v37
    v_add_f32 v155, v38, v39
    v_add_f32 v156, v40, v41
    v_add_f32 v157, v42, v43
    v_add_f32 v158, v44, v45
    v_add_f32 v159, v46, v47
    v_mul_f32 v32, v32, v96
    v_mul_f32 v34, v34, v98
    v_mul_f32 v36, v36, v100
    v_mul_f32 v38, v38, v102
    v_mul_f32 v40, v40, v104
    v_mul_f32 v42, v42, v106
    v_mul_f32 v44, v44, v108
    v_mul_f32 v46, v46, v110
    v_fmac_f32 v32, v33, v97
    v_fmac_f32 v34, v35, v99
    v_fmac_f32 v36, v37, v101
    v_fmac_f32 v38, v39, v103
    v_fmac_f32 v40, v41, v105
    v_fmac_f32 v42, v43, v107
    v_fmac_f32 v44, v45, v109
    v_fmac_f32 v46, v47, v111
    s_setprio 1
    s_waitcnt lgkmcnt(0)
    buffer_load_dword v96, v160, s[52:55], 0 offen offset:0
    buffer_load_dword v97, v161, s[52:55], 0 offen offset:0
    s_cmp_lg_u32 s5, 0
    s_cbranch_scc1 E_ndB3
    s_add_u32 s21, s21, 2048
    s_and_b32 s21, s21, 0x1fff
    s_add_u32 s33, s20, s21
    s_mov_b32 m0, s33
    s_nop 0
    buffer_load_dwordx4 v207, s[56:59], 0 offen lds
E_ndB3:
    buffer_load_dword v98, v162, s[52:55], 0 offen offset:0
    buffer_load_dword v99, v163, s[52:55], 0 offen offset:0
    buffer_load_dword v100, v164, s[52:55], 0 offen offset:0
    buffer_load_dword v101, v165, s[52:55], 0 offen offset:0
    buffer_load_dword v102, v166, s[52:55], 0 offen offset:0
    buffer_load_dword v103, v167, s[52:55], 0 offen offset:0
    s_setprio 3
    v_cmp_gt_u32 vcc, v212, v214
    s_setprio 1
    s_cbranch_vccnz E_slB1
E_slB1r:
    v_cvt_pk_bf16_f32 v152, v152, v32
    v_cvt_pk_bf16_f32 v153, v153, v34
    v_cvt_pk_bf16_f32 v154, v154, v36
    v_cvt_pk_bf16_f32 v155, v155, v38
    v_cvt_pk_bf16_f32 v156, v156, v40
    v_cvt_pk_bf16_f32 v157, v157, v42
    v_cvt_pk_bf16_f32 v158, v158, v44
    v_cvt_pk_bf16_f32 v159, v159, v46
    v_exp_f32 v48, v48
    v_exp_f32 v49, v49
    v_smfmac_f32_32x32x32_bf16 v[0:15], v[144:147], v[152:159], v203
    v_exp_f32 v50, v50
    v_exp_f32 v51, v51
    v_exp_f32 v52, v52
    v_exp_f32 v53, v53
    v_exp_f32 v54, v54
    v_mfma_f32_32x32x16_bf16 v[32:47], v[192:195], v[176:179], 0
    v_exp_f32 v55, v55
    v_exp_f32 v56, v56
    v_exp_f32 v57, v57
    v_exp_f32 v58, v58
    v_exp_f32 v59, v59
    v_mfma_f32_32x32x16_bf16 v[32:47], v[196:199], v[184:187], v[32:47]
    v_exp_f32 v60, v60
    v_exp_f32 v61, v61
    v_exp_f32 v62, v62
    v_exp_f32 v63, v63
    s_setprio 3
    v_add_f32 v48, 1.0, v48
    v_add_f32 v49, 1.0, v49
    v_add_f32 v50, 1.0, v50
    v_add_f32 v51, 1.0, v51
    v_add_f32 v52, 1.0, v52
    v_add_f32 v53, 1.0, v53
    v_add_f32 v54, 1.0, v54
    v_add_f32 v55, 1.0, v55
    v_add_f32 v56, 1.0, v56
    v_add_f32 v57, 1.0, v57
    v_add_f32 v58, 1.0, v58
    v_add_f32 v59, 1.0, v59
    v_add_f32 v60, 1.0, v60
    v_add_f32 v61, 1.0, v61
    v_add_f32 v62, 1.0, v62
    v_add_f32 v63, 1.0, v63
    v_add_u32 v201, 1024, v201
    v_add_u32 v202, 1024, v202
    v_add_u32 v204, 256, v204
    v_add_u32 v205, 256, v205
    v_add_u32 v200, 1024, v200
    v_add_u32 v212, 1, v212
    s_setprio 1
    buffer_load_dword v104, v168, s[52:55], 0 offen offset:0
    buffer_load_dword v105, v169, s[52:55], 0 offen offset:0
    buffer_load_dword v106, v170, s[52:55], 0 offen offset:0
    buffer_load_dword v107, v171, s[52:55], 0 offen offset:0
    buffer_load_dword v108, v172, s[52:55], 0 offen offset:0
    buffer_load_dword v109, v173, s[52:55], 0 offen offset:0
    buffer_load_dword v110, v174, s[52:55], 0 offen offset:0
    buffer_load_dword v111, v175, s[52:55], 0 offen offset:0
    s_add_u32 s23, s23, 1
    s_cmp_lt_u32 s23, s96
    s_waitcnt vmcnt(32)
    ds_write_b32 v248, v213
    v_rcp_f32 v48, v48
    v_rcp_f32 v49, v49
    v_smfmac_f32_32x32x32_bf16 v[32:47], v[128:131], v[64:71], v203 abid:1
    v_rcp_f32 v50, v50
    v_rcp_f32 v51, v51
    v_rcp_f32 v52, v52
    v_rcp_f32 v53, v53
    v_rcp_f32 v54, v54
    v_rcp_f32 v55, v55
    v_rcp_f32 v56, v56
    v_smfmac_f32_32x32x32_bf16 v[32:47], v[132:135], v[72:79], v203 abid:1
    v_rcp_f32 v57, v57
    v_rcp_f32 v58, v58
    v_rcp_f32 v59, v59
    v_rcp_f32 v60, v60
    v_rcp_f32 v61, v61
    v_rcp_f32 v62, v62
    v_rcp_f32 v63, v63
    s_setprio 3
    v_add_f32 v152, v48, v49
    v_add_f32 v153, v50, v51
    v_add_f32 v154, v52, v53
    v_add_f32 v155, v54, v55
    v_add_f32 v156, v56, v57
    v_add_f32 v157, v58, v59
    v_add_f32 v158, v60, v61
    v_add_f32 v159, v62, v63
    v_mul_f32 v48, v48, v112
    v_mul_f32 v50, v50, v114
    v_mul_f32 v52, v52, v116
    v_mul_f32 v54, v54, v118
    v_mul_f32 v56, v56, v120
    v_mul_f32 v58, v58, v122
    v_mul_f32 v60, v60, v124
    v_mul_f32 v62, v62, v126
    v_fmac_f32 v48, v49, v113
    v_fmac_f32 v50, v51, v115
    v_fmac_f32 v52, v53, v117
    v_fmac_f32 v54, v55, v119
    v_fmac_f32 v56, v57, v121
    v_fmac_f32 v58, v59, v123
    v_fmac_f32 v60, v61, v125
    v_fmac_f32 v62, v63, v127
    s_setprio 1
    s_cbranch_scc1 E_loopB
E_fin:
    v_cvt_pk_bf16_f32 v152, v152, v48
    v_cvt_pk_bf16_f32 v153, v153, v50
    v_cvt_pk_bf16_f32 v154, v154, v52
    v_cvt_pk_bf16_f32 v155, v155, v54
    v_cvt_pk_bf16_f32 v156, v156, v56
    v_cvt_pk_bf16_f32 v157, v157, v58
    v_cvt_pk_bf16_f32 v158, v158, v60
    v_cvt_pk_bf16_f32 v159, v159, v62
    s_setprio 0
    s_nop 0
    v_smfmac_f32_32x32x32_bf16 v[16:31], v[144:147], v[152:159], v203
E_done:
    s_or_b32 s33, s98, s99
    s_cmp_eq_u32 s33, 0
    s_cbranch_scc1 E_epi
    s_waitcnt vmcnt(0) lgkmcnt(0)
    s_add_u32 s12, s30, 0xe01000
    s_addc_u32 s13, s31, 0
    s_mov_b32 s14, 0x811000
    s_mov_b32 s15, 0x20000
    s_add_u32 s16, s30, 0xe00000
    s_addc_u32 s17, s31, 0
    s_mov_b32 s18, 0x1f4
    s_mov_b32 s19, 0x20000
    s_cmp_lg_u32 s6, 0
    s_cbranch_scc1 E_nc0
    v_mov_b32 v32, 2112
    ds_read_b128 v[36:39], v32
    ds_read_b128 v[40:43], v32 offset:16
    s_waitcnt lgkmcnt(0)

    v_readfirstlane_b32 s80, v36
    v_readfirstlane_b32 s81, v37
    v_readfirstlane_b32 s82, v38
    v_readfirstlane_b32 s83, v39
    v_readfirstlane_b32 s84, v40
    v_readfirstlane_b32 s85, v41
    v_readfirstlane_b32 s86, v42
    v_readfirstlane_b32 s87, v43
E_nc0:
    s_cmp_lg_u32 s98, 0
    s_cbranch_scc1 E_more_pend
E_nextchunk:
    s_cmp_eq_u64 s[80:81], 0
    s_cbranch_scc1 E_nc10
    s_ff1_i32_b64 s7, s[80:81]
    s_bitset0_b64 s[80:81], s7
    s_lshr_b32 s7, s7, 1
    s_add_u32 s7, s7, 0

    s_branch E_nc2
E_nc10:
    s_cmp_eq_u64 s[82:83], 0
    s_cbranch_scc1 E_nc11
    s_ff1_i32_b64 s7, s[82:83]
    s_bitset0_b64 s[82:83], s7
    s_lshr_b32 s7, s7, 1
    s_add_u32 s7, s7, 32

    s_branch E_nc2
E_nc11:
    s_cmp_eq_u64 s[84:85], 0
    s_cbranch_scc1 E_nc12
    s_ff1_i32_b64 s7, s[84:85]
    s_bitset0_b64 s[84:85], s7
    s_lshr_b32 s7, s7, 1
    s_add_u32 s7, s7, 64

    s_branch E_nc2
E_nc12:
    s_cmp_eq_u64 s[86:87], 0
    s_cbranch_scc1 E_epi
    s_ff1_i32_b64 s7, s[86:87]
    s_bitset0_b64 s[86:87], s7
    s_lshr_b32 s7, s7, 1
    s_add_u32 s7, s7, 96

E_nc2:
    s_lshl_b32 s33, s7, 2
    s_buffer_load_dword s34, s[16:19], s33
    s_waitcnt lgkmcnt(0)
    s_cmp_eq_u32 s34, 0
    s_cbranch_scc1 E_nextchunk
    s_mul_i32 s33, s7, 12800
    v_lshlrev_b32 v32, 5, v209
    v_add_u32 v32, s33, v32
    v_add_u32 v33, 0x200000, v32

    buffer_load_dwordx4 v[64:67], v32, s[12:15], 0 offen offset:0
    buffer_load_dwordx4 v[72:75], v33, s[12:15], 0 offen offset:0
    buffer_load_dwordx4 v[68:71], v32, s[12:15], 0 offen offset:16
    buffer_load_dwordx4 v[76:79], v33, s[12:15], 0 offen offset:16
    v_lshlrev_b32 v34, 3, v209
    s_lshl_b32 s25, s7, 4
    s_mov_b32 s24, 0
    s_waitcnt vmcnt(0)

    v_add_u32 v35, 0, v34
    v_cmp_gt_u32 vcc, s34, v35
    v_cmp_eq_u32 s[32:33], s2, v72
    s_and_b64 vcc, vcc, s[32:33]
    s_nop 1
    v_cndmask_b32 v64, 0, v64, vcc
    v_add_u32 v35, 1, v34
    v_cmp_gt_u32 vcc, s34, v35
    v_cmp_eq_u32 s[32:33], s2, v73
    s_and_b64 vcc, vcc, s[32:33]
    s_nop 1
    v_cndmask_b32 v65, 0, v65, vcc
    v_add_u32 v35, 2, v34
    v_cmp_gt_u32 vcc, s34, v35
    v_cmp_eq_u32 s[32:33], s2, v74
    s_and_b64 vcc, vcc, s[32:33]
    s_nop 1
    v_cndmask_b32 v66, 0, v66, vcc
    v_add_u32 v35, 3, v34
    v_cmp_gt_u32 vcc, s34, v35
    v_cmp_eq_u32 s[32:33], s2, v75
    s_and_b64 vcc, vcc, s[32:33]
    s_nop 1
    v_cndmask_b32 v67, 0, v67, vcc
    v_add_u32 v35, 4, v34
    v_cmp_gt_u32 vcc, s34, v35
    v_cmp_eq_u32 s[32:33], s2, v76
    s_and_b64 vcc, vcc, s[32:33]
    s_nop 1
    v_cndmask_b32 v68, 0, v68, vcc
    v_add_u32 v35, 5, v34
    v_cmp_gt_u32 vcc, s34, v35
    v_cmp_eq_u32 s[32:33], s2, v77
    s_and_b64 vcc, vcc, s[32:33]
    s_nop 1
    v_cndmask_b32 v69, 0, v69, vcc
    v_add_u32 v35, 6, v34
    v_cmp_gt_u32 vcc, s34, v35
    v_cmp_eq_u32 s[32:33], s2, v78
    s_and_b64 vcc, vcc, s[32:33]
    s_nop 1
    v_cndmask_b32 v70, 0, v70, vcc
    v_add_u32 v35, 7, v34
    v_cmp_gt_u32 vcc, s34, v35
    v_cmp_eq_u32 s[32:33], s2, v79
    s_and_b64 vcc, vcc, s[32:33]
    s_nop 1
    v_cndmask_b32 v71, 0, v71, vcc
    s_branch E_again
E_more_pend:
    s_lshl_b32 s33, s2, 14
    s_add_u32 s33, s33, 0x411000
    v_lshlrev_b32 v32, 5, v209
    v_add_u32 v32, s33, v32

    buffer_load_dwordx4 v[64:67], v32, s[12:15], 0 offen offset:0
    buffer_load_dwordx4 v[68:71], v32, s[12:15], 0 offen offset:16
E_again:
    s_mov_b32 s6, 1
    s_waitcnt vmcnt(0) lgkmcnt(0)
    s_barrier
    s_branch E_round

E_slA0p:
    ds_read_b32 v214, v215 offset:4
    ds_read_b128 v[192:195], v200
    s_waitcnt lgkmcnt(0)
    v_cmp_gt_u32 vcc, v212, v214
    s_cbranch_vccnz E_slA0p
    s_branch E_slA0pr
E_slA0:
    ds_read_b32 v214, v215 offset:4
    ds_read_b128 v[192:195], v200
    s_waitcnt lgkmcnt(0)
    v_cmp_gt_u32 vcc, v212, v214
    s_cbranch_vccnz E_slA0
    s_branch E_slA0r
E_slA1:
    ds_read_b32 v214, v215 offset:0
    ds_read_b128 v[192:195], v200
    s_waitcnt lgkmcnt(0)
    v_cmp_gt_u32 vcc, v212, v214
    s_cbranch_vccnz E_slA1
    s_branch E_slA1r
E_slB0p:
    ds_read_b32 v214, v215 offset:4
    ds_read_b128 v[192:195], v200
    s_waitcnt lgkmcnt(0)
    v_cmp_gt_u32 vcc, v212, v214
    s_cbranch_vccnz E_slB0p
    s_branch E_slB0pr
E_slB0:
    ds_read_b32 v214, v215 offset:4
    ds_read_b128 v[192:195], v200
    s_waitcnt lgkmcnt(0)
    v_cmp_gt_u32 vcc, v212, v214
    s_cbranch_vccnz E_slB0
    s_branch E_slB0r
E_slB1:
    ds_read_b32 v214, v215 offset:0
    ds_read_b128 v[192:195], v200
    s_waitcnt lgkmcnt(0)
    v_cmp_gt_u32 vcc, v212, v214
    s_cbranch_vccnz E_slB1
    s_branch E_slB1r
E_epi:
    s_mov_b32 s16, s26
    s_mov_b32 s17, s27
    s_mov_b32 s18, 0x30d400
    s_mov_b32 s19, 0x20000
    v_rcp_f32 v8, v8
    v_rcp_f32 v9, v9
    v_rcp_f32 v10, v10
    v_rcp_f32 v11, v11
    v_rcp_f32 v12, v12
    v_rcp_f32 v13, v13
    v_rcp_f32 v14, v14
    v_rcp_f32 v15, v15
    v_rcp_f32 v24, v24
    v_rcp_f32 v25, v25
    v_rcp_f32 v26, v26
    v_rcp_f32 v27, v27
    v_rcp_f32 v28, v28
    v_rcp_f32 v29, v29
    v_rcp_f32 v30, v30
    v_rcp_f32 v31, v31
    v_fma_f32 v0, v0, v8, v232
    v_fma_f32 v1, v1, v9, v233
    v_fma_f32 v2, v2, v10, v234
    v_fma_f32 v3, v3, v11, v235
    v_fma_f32 v4, v4, v12, v236
    v_fma_f32 v5, v5, v13, v237
    v_fma_f32 v6, v6, v14, v238
    v_fma_f32 v7, v7, v15, v239
    v_fma_f32 v16, v16, v24, v240
    v_fma_f32 v17, v17, v25, v241
    v_fma_f32 v18, v18, v26, v242
    v_fma_f32 v19, v19, v27, v243
    v_fma_f32 v20, v20, v28, v244
    v_fma_f32 v21, v21, v29, v245
    v_fma_f32 v22, v22, v30, v246
    v_fma_f32 v23, v23, v31, v247
    v_max_f32 v0, 0, v0
    v_max_f32 v1, 0, v1
    v_max_f32 v2, 0, v2
    v_max_f32 v3, 0, v3
    v_max_f32 v4, 0, v4
    v_max_f32 v5, 0, v5
    v_max_f32 v6, 0, v6
    v_max_f32 v7, 0, v7
    v_max_f32 v16, 0, v16
    v_max_f32 v17, 0, v17
    v_max_f32 v18, 0, v18
    v_max_f32 v19, 0, v19
    v_max_f32 v20, 0, v20
    v_max_f32 v21, 0, v21
    v_max_f32 v22, 0, v22
    v_max_f32 v23, 0, v23
    v_add_f32 v0, v0, v216
    v_add_f32 v1, v1, v217
    v_add_f32 v2, v2, v218
    v_add_f32 v3, v3, v219
    v_add_f32 v4, v4, v220
    v_add_f32 v5, v5, v221
    v_add_f32 v6, v6, v222
    v_add_f32 v7, v7, v223
    v_add_f32 v16, v16, v224
    v_add_f32 v17, v17, v225
    v_add_f32 v18, v18, v226
    v_add_f32 v19, v19, v227
    v_add_f32 v20, v20, v228
    v_add_f32 v21, v21, v229
    v_add_f32 v22, v22, v230
    v_add_f32 v23, v23, v231
    v_cvt_pk_bf16_f32 v0, v0, v16
    v_cvt_pk_bf16_f32 v1, v1, v17
    v_cvt_pk_bf16_f32 v2, v2, v18
    v_cvt_pk_bf16_f32 v3, v3, v19
    v_cvt_pk_bf16_f32 v4, v4, v20
    v_cvt_pk_bf16_f32 v5, v5, v21
    v_cvt_pk_bf16_f32 v6, v6, v22
    v_cvt_pk_bf16_f32 v7, v7, v23
    buffer_store_dword v0, v250, s[16:19], 0 offen offset:0 sc1
    buffer_store_dword v1, v250, s[16:19], 0 offen offset:1024 sc1
    buffer_store_dword v2, v250, s[16:19], 0 offen offset:2048 sc1
    buffer_store_dword v3, v250, s[16:19], 0 offen offset:3072 sc1
    s_cmp_eq_u32 s4, 0
    s_cselect_b32 exec_hi, -1, 0
    buffer_store_dword v4, v252, s[16:19], 0 offen offset:0 sc1
    s_mov_b32 exec_hi, 0
    buffer_store_dword v5, v252, s[16:19], 0 offen offset:1024 sc1
    buffer_store_dword v6, v252, s[16:19], 0 offen offset:2048 sc1
    buffer_store_dword v7, v252, s[16:19], 0 offen offset:3072 sc1
E_end:
    s_endpgm
.section .rodata,"a"
.p2align 6
.amdhsa_kernel prep_kernel
  .amdhsa_next_free_vgpr 208
  .amdhsa_next_free_sgpr 96
  .amdhsa_accum_offset 208
  .amdhsa_group_segment_fixed_size 0
  .amdhsa_kernarg_size 96
  .amdhsa_user_sgpr_count 2
  .amdhsa_user_sgpr_kernarg_segment_ptr 1
  .amdhsa_system_sgpr_workgroup_id_x 1
.end_amdhsa_kernel
.p2align 6
.amdhsa_kernel edge_kernel
  .amdhsa_next_free_vgpr 256
  .amdhsa_next_free_sgpr 102
  .amdhsa_accum_offset 256
  .amdhsa_group_segment_fixed_size 0
  .amdhsa_kernarg_size 96
  .amdhsa_user_sgpr_count 2
  .amdhsa_user_sgpr_kernarg_segment_ptr 1
  .amdhsa_system_sgpr_workgroup_id_x 1
.end_amdhsa_kernel
```
